```python
import torch

def _softmax(x, axis=-1):
    return torch.softmax(x, dim=axis)
def _gelu(x):
    return torch.nn.functional.gelu(x, approximate="tanh")
def _silu(x):
    return torch.nn.functional.silu(x)
def _sigmoid(x):
    return torch.sigmoid(x)
def _layernorm(x, axis=-1, eps=1e-5):
    m = x.mean(dim=axis, keepdim=True)
    v = x.var(dim=axis, keepdim=True, unbiased=False)
    return (x - m) / torch.sqrt(v + eps)
def _scatter_add(tgt, idx, src, axis=0):
    return tgt.clone().index_add_(axis, idx, src)
def _segment_sum(src, seg, n):
    out = torch.zeros((n,) + src.shape[1:], dtype=src.dtype)
    return out.index_add_(0, seg, src)
def _pad(x, pw):
    flat = tuple(v for pair in reversed(pw) for v in pair)
    return torch.nn.functional.pad(x, flat)

kernel_name = 'concat_heads__sliding_block_cached__gqa_block_cached__decode'

def setup_inputs():

    _w = (lambda a: (lambda t: t.to(torch.bfloat16) if t.is_floating_point() else t)(torch.as_tensor(a)))
    def _A_setup():
        B, Sq, D = 8, 1, 512
        Hq, Hkv, Sk, Dh = 32, 8, 4096, 128
        assert Hq % Hkv == 0, (Hq, Hkv)
        return {
            "x": _w((lambda *s: torch.randn(*s, dtype=torch.bfloat16) * 0.8)(B, Sq, D)),
            "k_cache": _w((lambda *s: torch.randn(*s, dtype=torch.bfloat16) * 1.6)(B, Hkv, Sk, Dh)),
            "v_cache": _w((lambda *s: torch.randn(*s, dtype=torch.bfloat16) * 0.2)(B, Hkv, Sk, Dh)),
            "wq": _w((lambda *s: torch.randn(*s, dtype=torch.bfloat16) * 1.6)(D, Hq * Dh) * (D ** -0.5)),
            "wo": _w((lambda *s: torch.randn(*s, dtype=torch.bfloat16) * 0.2)(Hq * Dh, D) * ((Hq * Dh) ** -0.5)),
        }
    _A_in = _A_setup()

    def _B_setup():
        B, Sq, D = 8, 1, 512
        Hq, Hkv, Sk, Dh = 32, 8, 4096, 128
        assert Hq % Hkv == 0, (Hq, Hkv)
        return {
            "x": _w((lambda *s: torch.randn(*s, dtype=torch.bfloat16) * 0.8)(B, Sq, D)),
            "k_cache": _w((lambda *s: torch.randn(*s, dtype=torch.bfloat16) * 1.6)(B, Hkv, Sk, Dh)),
            "v_cache": _w((lambda *s: torch.randn(*s, dtype=torch.bfloat16) * 0.2)(B, Hkv, Sk, Dh)),
            "wq": _w((lambda *s: torch.randn(*s, dtype=torch.bfloat16) * 1.6)(D, Hq * Dh) * (D ** -0.5)),
            "wo": _w((lambda *s: torch.randn(*s, dtype=torch.bfloat16) * 0.2)(Hq * Dh, D) * ((Hq * Dh) ** -0.5)),
        }
    _B_in = _B_setup()

    return {
        "A_x": _A_in["x"],
        "A_k_cache": _A_in["k_cache"],
        "A_v_cache": _A_in["v_cache"],
        "A_wq": _A_in["wq"],
        "A_wo": _A_in["wo"],
        "B_x": _B_in["x"],
        "B_k_cache": _B_in["k_cache"],
        "B_v_cache": _B_in["v_cache"],
        "B_wq": _B_in["wq"],
        "B_wo": _B_in["wo"],
    }

def reference(A_x, A_k_cache, A_v_cache, A_wq, A_wo, B_x, B_k_cache, B_v_cache, B_wq, B_wo):
    def _A_ref(x, k_cache, v_cache, wq, wo):
        B, Sq, D = x.shape
        Hq, Dh = 32, 128
        Hkv, Sk = k_cache.shape[1], k_cache.shape[2]
        W = min(4096, max(256, Sk // 4))
        rep = Hq // Hkv
        q = (lambda x, *d: x.permute(*d))((x @ wq).reshape(B, Sq, Hq, Dh), 0, 2, 1, 3)
        k = (lambda x, n, axis: torch.repeat_interleave(x, n, dim=axis))(k_cache[:, :, Sk - W:, :], rep, axis=1)
        v = (lambda x, n, axis: torch.repeat_interleave(x, n, dim=axis))(v_cache[:, :, Sk - W:, :], rep, axis=1)
        scores = torch.einsum("bhqd,bhkd->bhqk", q, k) * (Dh ** -0.5)
        p = _softmax(scores, axis=-1)
        o = torch.einsum("bhqk,bhkd->bhqd", p, v)
        return (lambda x, *d: x.permute(*d))(o, 0, 2, 1, 3).reshape(B, Sq, Hq * Dh) @ wo

    def _B_ref(x, k_cache, v_cache, wq, wo):
        B, Sq, D = x.shape
        Hq, Dh = 32, 128
        Hkv = k_cache.shape[1]
        rep = Hq // Hkv
        q = (lambda x, *d: x.permute(*d))((x @ wq).reshape(B, Sq, Hq, Dh), 0, 2, 1, 3)
        k = (lambda x, n, axis: torch.repeat_interleave(x, n, dim=axis))(k_cache, rep, axis=1)
        v = (lambda x, n, axis: torch.repeat_interleave(x, n, dim=axis))(v_cache, rep, axis=1)
        scores = torch.einsum("bhqd,bhkd->bhqk", q, k) * (Dh ** -0.5)
        p = _softmax(scores, axis=-1)
        o = torch.einsum("bhqk,bhkd->bhqd", p, v)
        return (lambda x, *d: x.permute(*d))(o, 0, 2, 1, 3).reshape(B, Sq, Hq * Dh) @ wo

    a = _A_ref(A_x, A_k_cache, A_v_cache, A_wq, A_wo)
    b = _B_ref(B_x, B_k_cache, B_v_cache, B_wq, B_wo)
    return torch.concatenate([a, b], axis=-1)
```

```asm
; @launch grid=(256,1,1) block=(768,1,1) lds=152384
.amdgcn_target "amdgcn-amd-amdhsa--gfx950"
.text
.p2align 12
.globl concat_heads__sliding_block_cached__gqa_block_cached__decode_kernel
.p2align 8
.type concat_heads__sliding_block_cached__gqa_block_cached__decode_kernel,@function
concat_heads__sliding_block_cached__gqa_block_cached__decode_kernel:
s_cmp_ge_u32 s2, 256
s_cbranch_scc1 L_end
s_load_dwordx16 s[16:31], s[0:1], 0
s_load_dwordx8 s[32:39], s[0:1], 64
s_load_dwordx2 s[40:41], s[0:1], 96
v_lshrrev_b32 v1, 6, v0
v_and_b32 v0, 63, v0
v_readfirstlane_b32 s3, v1
s_and_b32 s4, s2, 7
s_lshr_b32 s5, s2, 3
s_and_b32 s6, s5, 7
s_lshr_b32 s7, s5, 3
s_cmp_eq_u32 s3, 2
s_cbranch_scc0 L_t01
s_lshl_b32 s15, s6, 3
s_add_u32 s15, s15, s4
s_lshl_b32 s15, s15, 20
s_lshl_b32 s14, s7, 18
s_add_u32 s14, s14, s15
s_add_u32 s15, s15, 786432
s_lshl_b32 s13, s4, 19
s_cmp_lt_u32 s2, 128
s_waitcnt lgkmcnt(0)
s_cselect_b64 s[64:65], s[24:25], s[34:35]
s_cselect_b64 s[66:67], s[16:17], s[26:27]
s_load_dword s100, s[28:29], s14
s_load_dword s100, s[66:67], 0
s_load_dword s100, s[40:41], 0x100
L_t01:
s_cmp_eq_u32 s3, 0
s_cbranch_scc1 L_loader
s_barrier
s_cmp_eq_u32 s3, 1
s_cbranch_scc1 L_service
s_branch L_attn
L_loader:
s_setprio 3
v_lshlrev_b32 v13, 2, v0
v_add_u32 v13, 152000, v13
v_mov_b32 v15, 0
ds_write_b32 v13, v15
v_and_b32 v3, 7, v0
v_lshrrev_b32 v8, 3, v0
v_lshlrev_b32 v8, 13, v8
v_lshl_add_u32 v8, v3, 4, v8
v_add_u32 v9, 0xfc00, v8
v_add_u32 v10, 0x1f800, v8
v_add_u32 v11, 0x2f400, v8
s_bfe_u32 s15, s2, 0x30004
s_lshl_b32 s15, s15, 10
s_lshl_b32 s11, s4, 7
s_add_u32 s15, s15, s11
s_bfe_u32 s11, s2, 0x10003
s_lshl_b32 s11, s11, 21
s_add_u32 s15, s15, s11
s_mov_b32 s50, 0x400000
s_mov_b32 s51, 0x20000
s_mov_b32 m0, 0
s_mov_b32 s12, 0
s_cmp_lt_u32 s2, 128
s_waitcnt lgkmcnt(0)
s_cselect_b64 s[48:49], s[22:23], s[32:33]
L_lwq:
buffer_load_dwordx4 v8, s[48:51], s15 offen offset:0 nt lds
buffer_load_dwordx4 v9, s[48:51], s15 offen offset:1024 nt lds
buffer_load_dwordx4 v10, s[48:51], s15 offen offset:2048 nt lds
buffer_load_dwordx4 v11, s[48:51], s15 offen offset:3072 nt lds
s_add_u32 m0, m0, 4096
s_add_u32 s15, s15, 0x40000
s_add_u32 s12, s12, 1
s_cmp_lt_u32 s12, 8
s_cbranch_scc1 L_lwq
s_barrier
v_lshrrev_b32 v4, 4, v0
v_and_b32 v5, 15, v0
v_lshlrev_b32 v13, 2, v0
v_add_u32 v13, 152000, v13
v_mov_b32 v7, 2
v_xor_b32 v6, v4, v5
v_lshlrev_b32 v6, 4, v6
v_lshl_add_u32 v8, v4, 8, v6
v_xor_b32 v9, 64, v8
v_xor_b32 v10, 128, v8
v_xor_b32 v11, 192, v8
v_add_u32 v9, 7168, v9
v_add_u32 v10, 2048, v10
v_add_u32 v11, 9216, v11
s_lshl_b32 s9, s6, 3
s_add_u32 s9, s9, s4
s_lshl_b32 s9, s9, 20
s_lshl_b32 s11, s7, 18
s_add_u32 s56, s9, s11
s_lshl_b32 s11, s7, 16
s_add_u32 s57, s9, s11
s_add_u32 s57, s57, 786432
s_mul_i32 s58, s2, 0x9E3779B1
s_bfe_u32 s59, s58, 0x2001a
s_lshr_b32 s58, s58, 28
s_lshl_b32 s58, s58, 14
s_lshl_b32 s59, s59, 14
s_mov_b32 s50, 0x4000000
s_mov_b64 s[48:49], s[28:29]
s_mov_b32 s60, 0x3ffff
s_mov_b32 s61, 16
s_mov_b32 s62, 0
s_mov_b32 s12, 0
s_mov_b32 s14, 0
s_mov_b32 m0, 65536
v_mov_b32 v15, 0
v_lshlrev_b32 v16, 10, v4
v_lshl_add_u32 v16, v5, 4, v16
v_and_b32 v17, 32, v0
v_lshlrev_b32 v17, 2, v17
v_xor_b32 v16, v16, v17
v_add_u32 v17, 3072, v16
v_xor_b32 v18, 32, v16
v_add_u32 v19, 9216, v18
v_add_u32 v18, 6144, v18
s_lshl_b32 s44, s4, 2
s_bfe_u32 s11, s5, 0x20002
s_add_u32 s44, s44, s11
s_lshl_b32 s44, s44, 17
s_and_b32 s11, s5, 3
s_lshl_b32 s11, s11, 8
s_add_u32 s44, s44, s11
s_cmp_lt_u32 s5, 16
s_cselect_b64 s[52:53], s[24:25], s[34:35]
s_mov_b32 s54, 0x400000
s_mov_b32 s55, 0x20000
L_lga:
s_add_u32 s15, s56, s58
s_add_u32 s58, s58, 0x4000
s_and_b32 s58, s58, s60
s_waitcnt lgkmcnt(1)
v_readlane_b32 s42, v15, s12
v_readlane_b32 s46, v15, 26
s_cmp_lt_i32 s42, s14
s_cbranch_scc1 L_lfr
L_lfd:
s_cmp_lg_u32 s46, 0
s_cbranch_scc1 L_lhi
s_waitcnt vmcnt(19)
buffer_load_dwordx4 v8, s[48:51], s15 offen offset:0 nt lds
s_waitcnt vmcnt(19)
buffer_load_dwordx4 v9, s[48:51], s15 offen offset:1024 nt lds
s_waitcnt vmcnt(19)
buffer_load_dwordx4 v10, s[48:51], s15 offen offset:2048 nt lds
s_waitcnt vmcnt(19)
buffer_load_dwordx4 v11, s[48:51], s15 offen offset:3072 nt lds
ds_write_b32 v13, v7 offset:128
v_add_u32 v7, 1, v7
s_add_u32 m0, m0, 4096
s_add_u32 s15, s15, 1024
s_waitcnt vmcnt(19)
buffer_load_dwordx4 v8, s[48:51], s15 offen offset:0 nt lds
s_waitcnt vmcnt(19)
buffer_load_dwordx4 v9, s[48:51], s15 offen offset:1024 nt lds
s_waitcnt vmcnt(19)
buffer_load_dwordx4 v10, s[48:51], s15 offen offset:2048 nt lds
s_waitcnt vmcnt(19)
buffer_load_dwordx4 v11, s[48:51], s15 offen offset:3072 nt lds
ds_write_b32 v13, v7 offset:128
v_add_u32 v7, 1, v7
s_add_u32 m0, m0, 4096
s_add_u32 s15, s15, 1024
s_waitcnt vmcnt(19)
buffer_load_dwordx4 v8, s[48:51], s15 offen offset:0 nt lds
s_waitcnt vmcnt(19)
buffer_load_dwordx4 v9, s[48:51], s15 offen offset:1024 nt lds
s_waitcnt vmcnt(19)
buffer_load_dwordx4 v10, s[48:51], s15 offen offset:2048 nt lds
s_waitcnt vmcnt(19)
buffer_load_dwordx4 v11, s[48:51], s15 offen offset:3072 nt lds
ds_write_b32 v13, v7 offset:128
v_add_u32 v7, 1, v7
s_add_u32 m0, m0, 4096
s_add_u32 s15, s15, 1024
s_waitcnt vmcnt(19)
buffer_load_dwordx4 v8, s[48:51], s15 offen offset:0 nt lds
s_waitcnt vmcnt(19)
buffer_load_dwordx4 v9, s[48:51], s15 offen offset:1024 nt lds
s_waitcnt vmcnt(19)
buffer_load_dwordx4 v10, s[48:51], s15 offen offset:2048 nt lds
s_waitcnt vmcnt(19)
buffer_load_dwordx4 v11, s[48:51], s15 offen offset:3072 nt lds
ds_read_b32 v15, v13
ds_write_b32 v13, v7 offset:128
v_add_u32 v7, 1, v7
s_add_u32 m0, m0, 4096
L_ljn:
s_add_u32 s12, s12, 1
s_cmp_eq_u32 s12, 5
s_cbranch_scc1 L_lwr
L_lnw:
s_sub_u32 s61, s61, 1
s_cmp_lg_u32 s61, 0
s_cbranch_scc1 L_lga
s_add_u32 s62, s62, 1
s_cmp_eq_u32 s62, 2
s_cbranch_scc1 L_lp2
s_cmp_eq_u32 s62, 4
s_cbranch_scc1 L_ldone
s_mov_b32 s63, s56
s_mov_b32 s56, s57
s_mov_b32 s57, s63
s_mov_b32 s63, s58
s_mov_b32 s58, s59
s_mov_b32 s59, s63
s_xor_b32 s60, s60, 0x30000
s_cmp_eq_u32 s62, 1
s_cselect_b64 s[48:49], s[18:19], s[30:31]
s_cselect_b32 s61, 4, 16
s_branch L_lga
L_lp2:
s_mov_b64 s[48:49], s[20:21]
s_mov_b32 s61, 4
v_lshlrev_b32 v8, 4, v0
v_lshlrev_b32 v9, 4, v0
v_lshlrev_b32 v10, 4, v0
v_lshlrev_b32 v11, 4, v0
v_add_u32 v9, 7168, v9
v_add_u32 v10, 2048, v10
v_add_u32 v11, 9216, v11
s_branch L_lga
L_lhi:
s_waitcnt vmcnt(27)
buffer_load_dwordx4 v8, s[48:51], s15 offen offset:0 nt lds
s_waitcnt vmcnt(27)
buffer_load_dwordx4 v9, s[48:51], s15 offen offset:1024 nt lds
s_waitcnt vmcnt(27)
buffer_load_dwordx4 v10, s[48:51], s15 offen offset:2048 nt lds
s_waitcnt vmcnt(27)
buffer_load_dwordx4 v11, s[48:51], s15 offen offset:3072 nt lds
ds_write_b32 v13, v7 offset:128
v_add_u32 v7, 1, v7
s_add_u32 m0, m0, 4096
s_add_u32 s15, s15, 1024
s_waitcnt vmcnt(27)
buffer_load_dwordx4 v8, s[48:51], s15 offen offset:0 nt lds
s_waitcnt vmcnt(27)
buffer_load_dwordx4 v9, s[48:51], s15 offen offset:1024 nt lds
s_waitcnt vmcnt(27)
buffer_load_dwordx4 v10, s[48:51], s15 offen offset:2048 nt lds
s_waitcnt vmcnt(27)
buffer_load_dwordx4 v11, s[48:51], s15 offen offset:3072 nt lds
ds_write_b32 v13, v7 offset:128
v_add_u32 v7, 1, v7
s_add_u32 m0, m0, 4096
s_add_u32 s15, s15, 1024
s_waitcnt vmcnt(27)
buffer_load_dwordx4 v8, s[48:51], s15 offen offset:0 nt lds
s_waitcnt vmcnt(27)
buffer_load_dwordx4 v9, s[48:51], s15 offen offset:1024 nt lds
s_waitcnt vmcnt(27)
buffer_load_dwordx4 v10, s[48:51], s15 offen offset:2048 nt lds
s_waitcnt vmcnt(27)
buffer_load_dwordx4 v11, s[48:51], s15 offen offset:3072 nt lds
ds_write_b32 v13, v7 offset:128
v_add_u32 v7, 1, v7
s_add_u32 m0, m0, 4096
s_add_u32 s15, s15, 1024
s_waitcnt vmcnt(27)
buffer_load_dwordx4 v8, s[48:51], s15 offen offset:0 nt lds
s_waitcnt vmcnt(27)
buffer_load_dwordx4 v9, s[48:51], s15 offen offset:1024 nt lds
s_waitcnt vmcnt(27)
buffer_load_dwordx4 v10, s[48:51], s15 offen offset:2048 nt lds
s_waitcnt vmcnt(27)
buffer_load_dwordx4 v11, s[48:51], s15 offen offset:3072 nt lds
ds_read_b32 v15, v13
ds_write_b32 v13, v7 offset:128
v_add_u32 v7, 1, v7
s_add_u32 m0, m0, 4096
s_branch L_ljn
L_lfr:
s_mov_b32 s43, 0
L_lfs:
ds_read_b32 v15, v13
s_waitcnt lgkmcnt(0)
v_readlane_b32 s42, v15, s12
s_cmp_ge_i32 s42, s14
s_cbranch_scc1 L_lfd
s_add_u32 s43, s43, 1
s_cmp_lt_u32 s43, 2097152
s_cbranch_scc1 L_lfs
s_branch L_lfd
L_lwr:
s_mov_b32 s12, 0
s_add_u32 s14, s14, 4
s_mov_b32 m0, 65536
s_branch L_lnw
L_ldone:
s_mov_b32 m0, 32768
s_mov_b32 s12, 0
L_lwo:
buffer_load_dwordx4 v16, s[52:55], s44 offen offset:0 nt lds
v_xor_b32 v16, 64, v16
buffer_load_dwordx4 v17, s[52:55], s44 offen offset:1024 nt lds
v_xor_b32 v17, 64, v17
buffer_load_dwordx4 v18, s[52:55], s44 offen offset:2048 nt lds
v_xor_b32 v18, 64, v18
buffer_load_dwordx4 v19, s[52:55], s44 offen offset:3072 nt lds
v_xor_b32 v19, 64, v19
s_add_u32 m0, m0, 4096
s_add_u32 s44, s44, 0x4000
s_add_u32 s12, s12, 1
s_cmp_lt_u32 s12, 8
s_cbranch_scc1 L_lwo
s_waitcnt vmcnt(56)
ds_write_b32 v13, v7 offset:128
v_add_u32 v7, 1, v7
s_waitcnt vmcnt(52)
ds_write_b32 v13, v7 offset:128
v_add_u32 v7, 1, v7
s_waitcnt vmcnt(48)
ds_write_b32 v13, v7 offset:128
v_add_u32 v7, 1, v7
s_waitcnt vmcnt(44)
ds_write_b32 v13, v7 offset:128
v_add_u32 v7, 1, v7
s_waitcnt vmcnt(40)
ds_write_b32 v13, v7 offset:128
v_add_u32 v7, 1, v7
s_waitcnt vmcnt(36)
ds_write_b32 v13, v7 offset:128
v_add_u32 v7, 1, v7
s_waitcnt vmcnt(32)
ds_write_b32 v13, v7 offset:128
v_add_u32 v7, 1, v7
s_barrier
v_mov_b32 v7, 172
s_waitcnt vmcnt(16)
ds_write_b32 v13, v7 offset:128
v_add_u32 v7, 1, v7
s_waitcnt vmcnt(12)
ds_write_b32 v13, v7 offset:128
v_add_u32 v7, 1, v7
s_waitcnt vmcnt(8)
ds_write_b32 v13, v7 offset:128
v_add_u32 v7, 1, v7
s_waitcnt vmcnt(4)
ds_write_b32 v13, v7 offset:128
v_add_u32 v7, 1, v7
s_waitcnt vmcnt(0)
ds_write_b32 v13, v7 offset:128
v_add_u32 v7, 1, v7
s_endpgm
L_service:
s_setprio 2
s_lshr_b32 s8, s2, 7
s_bfe_u32 s13, s2, 0x10003
s_bfe_u32 s15, s2, 0x30004
v_and_b32 v3, 7, v0
v_lshlrev_b32 v1, 10, v3
v_lshrrev_b32 v4, 4, v0
v_lshl_add_u32 v1, v4, 4, v1
s_lshl_b32 s10, s15, 10
s_lshl_b32 s11, s4, 7
s_add_u32 s10, s10, s11
s_lshl_b32 s12, s13, 9
s_mov_b32 s46, 8192
s_mov_b32 s47, 0x20000
s_mov_b32 s54, 3145728
s_mov_b32 s55, 0x20000
v_lshlrev_b32 v12, 2, v0
v_add_u32 v12, 152000, v12
v_mov_b32 v9, 0
v_mov_b32 v12, 152000
v_mov_b32 v9, 0
s_waitcnt lgkmcnt(0)
s_cmp_eq_u32 s8, 0
s_cselect_b32 s44, s16, s26
s_cselect_b32 s45, s17, s27
s_mov_b32 s52, s40
s_mov_b32 s53, s41
buffer_load_dwordx4 v[40:43], v1, s[44:47], s12 offen offset:0
buffer_load_dwordx4 v[44:47], v1, s[44:47], s12 offen offset:64
buffer_load_dwordx4 v[48:51], v1, s[44:47], s12 offen offset:128
buffer_load_dwordx4 v[52:55], v1, s[44:47], s12 offen offset:192
buffer_load_dwordx4 v[56:59], v1, s[44:47], s12 offen offset:256
buffer_load_dwordx4 v[60:63], v1, s[44:47], s12 offen offset:320
buffer_load_dwordx4 v[64:67], v1, s[44:47], s12 offen offset:384
buffer_load_dwordx4 v[68:71], v1, s[44:47], s12 offen offset:448
buffer_load_dword v10, v9, s[52:55], 0 offen sc1
v_lshlrev_b32 v5, 3, v4
v_bfe_u32 v6, v0, 2, 2
v_add_u32 v5, v5, v6
v_lshlrev_b32 v5, 7, v5
v_and_b32 v6, 3, v0
v_lshl_add_u32 v5, v6, 3, v5
v_lshlrev_b32 v6, 14, v3
v_bfe_u32 v7, v0, 3, 1
v_lshl_add_u32 v6, v7, 6, v6
v_lshl_add_u32 v6, v4, 4, v6
s_lshl_b32 s12, s8, 1
s_add_u32 s12, s12, s13
s_lshl_b32 s12, s12, 17
s_lshl_b32 s11, s10, 1
s_add_u32 s12, s12, s11
s_add_u32 s12, s12, 524288
v_and_b32 v7, 8, v0
v_cmp_eq_u32 vcc, 0, v7
v_lshlrev_b32 v4, 4, v0
s_mov_b32 s42, 0
s_waitcnt vmcnt(0)
v_readfirstlane_b32 s16, v10
s_and_b32 s17, s16, 0x00ff00ff
s_add_u32 s17, s17, 0x00050001
s_and_b32 s17, s17, 0x00ff00ff
s_and_b32 s16, s16, 0xff00ff00
s_add_u32 s16, s16, 0x07000300
s_and_b32 s16, s16, 0xff00ff00
s_or_b32 s16, s16, s17
s_and_b32 s17, s16, 63
s_bfe_u32 s18, s16, 0x60008
s_bfe_u32 s19, s16, 0x60010
s_bfe_u32 s20, s16, 0x60018
v_mov_b32 v14, 63
s_cmp_ge_i32 s42, 8
s_cbranch_scc1 L_wd3
s_mov_b32 s43, 0
L_wl2:
ds_read_b32 v8, v12 offset:128
s_waitcnt lgkmcnt(0)
v_readfirstlane_b32 s42, v8
s_cmp_ge_i32 s42, 8
s_cbranch_scc1 L_wd3
s_sleep 1
s_add_u32 s43, s43, 1
s_cmp_lt_u32 s43, 2097152
s_cbranch_scc1 L_wl2
L_wd3:
v_mov_b32 v8, 1
ds_write_b32 v12, v8 offset:104
ds_read_b64_tr_b16 v[104:105], v5 offset:0
ds_read_b64_tr_b16 v[106:107], v5 offset:512
ds_read_b64_tr_b16 v[108:109], v5 offset:32
ds_read_b64_tr_b16 v[110:111], v5 offset:544
ds_read_b64_tr_b16 v[112:113], v5 offset:64
ds_read_b64_tr_b16 v[114:115], v5 offset:576
ds_read_b64_tr_b16 v[116:117], v5 offset:96
ds_read_b64_tr_b16 v[118:119], v5 offset:608
ds_read_b64_tr_b16 v[120:121], v5 offset:4096
ds_read_b64_tr_b16 v[122:123], v5 offset:4608
ds_read_b64_tr_b16 v[124:125], v5 offset:4128
ds_read_b64_tr_b16 v[126:127], v5 offset:4640
s_waitcnt lgkmcnt(8)
v_mfma_f32_16x16x32_bf16 v[16:19], v[104:107], v[40:43], 0
v_mfma_f32_16x16x32_bf16 v[20:23], v[108:111], v[40:43], 0
ds_read_b64_tr_b16 v[104:105], v5 offset:4160
ds_read_b64_tr_b16 v[106:107], v5 offset:4672
ds_read_b64_tr_b16 v[108:109], v5 offset:4192
ds_read_b64_tr_b16 v[110:111], v5 offset:4704
s_waitcnt lgkmcnt(8)
v_mfma_f32_16x16x32_bf16 v[24:27], v[112:115], v[40:43], 0
v_mfma_f32_16x16x32_bf16 v[28:31], v[116:119], v[40:43], 0
ds_read_b64_tr_b16 v[112:113], v5 offset:8192
ds_read_b64_tr_b16 v[114:115], v5 offset:8704
ds_read_b64_tr_b16 v[116:117], v5 offset:8224
ds_read_b64_tr_b16 v[118:119], v5 offset:8736
s_waitcnt lgkmcnt(8)
v_mfma_f32_16x16x32_bf16 v[16:19], v[120:123], v[44:47], v[16:19]
v_mfma_f32_16x16x32_bf16 v[20:23], v[124:127], v[44:47], v[20:23]
ds_read_b64_tr_b16 v[120:121], v5 offset:8256
ds_read_b64_tr_b16 v[122:123], v5 offset:8768
ds_read_b64_tr_b16 v[124:125], v5 offset:8288
ds_read_b64_tr_b16 v[126:127], v5 offset:8800
s_waitcnt lgkmcnt(8)
v_mfma_f32_16x16x32_bf16 v[24:27], v[104:107], v[44:47], v[24:27]
v_mfma_f32_16x16x32_bf16 v[28:31], v[108:111], v[44:47], v[28:31]
ds_read_b64_tr_b16 v[104:105], v5 offset:12288
ds_read_b64_tr_b16 v[106:107], v5 offset:12800
ds_read_b64_tr_b16 v[108:109], v5 offset:12320
ds_read_b64_tr_b16 v[110:111], v5 offset:12832
s_waitcnt lgkmcnt(8)
v_mfma_f32_16x16x32_bf16 v[16:19], v[112:115], v[48:51], v[16:19]
v_mfma_f32_16x16x32_bf16 v[20:23], v[116:119], v[48:51], v[20:23]
ds_read_b64_tr_b16 v[112:113], v5 offset:12352
ds_read_b64_tr_b16 v[114:115], v5 offset:12864
ds_read_b64_tr_b16 v[116:117], v5 offset:12384
ds_read_b64_tr_b16 v[118:119], v5 offset:12896
s_waitcnt lgkmcnt(8)
v_mfma_f32_16x16x32_bf16 v[24:27], v[120:123], v[48:51], v[24:27]
v_mfma_f32_16x16x32_bf16 v[28:31], v[124:127], v[48:51], v[28:31]
ds_read_b64_tr_b16 v[120:121], v5 offset:16384
ds_read_b64_tr_b16 v[122:123], v5 offset:16896
ds_read_b64_tr_b16 v[124:125], v5 offset:16416
ds_read_b64_tr_b16 v[126:127], v5 offset:16928
s_waitcnt lgkmcnt(8)
v_mfma_f32_16x16x32_bf16 v[16:19], v[104:107], v[52:55], v[16:19]
v_mfma_f32_16x16x32_bf16 v[20:23], v[108:111], v[52:55], v[20:23]
ds_read_b64_tr_b16 v[104:105], v5 offset:16448
ds_read_b64_tr_b16 v[106:107], v5 offset:16960
ds_read_b64_tr_b16 v[108:109], v5 offset:16480
ds_read_b64_tr_b16 v[110:111], v5 offset:16992
s_waitcnt lgkmcnt(8)
v_mfma_f32_16x16x32_bf16 v[24:27], v[112:115], v[52:55], v[24:27]
v_mfma_f32_16x16x32_bf16 v[28:31], v[116:119], v[52:55], v[28:31]
ds_read_b64_tr_b16 v[112:113], v5 offset:20480
ds_read_b64_tr_b16 v[114:115], v5 offset:20992
ds_read_b64_tr_b16 v[116:117], v5 offset:20512
ds_read_b64_tr_b16 v[118:119], v5 offset:21024
s_waitcnt lgkmcnt(8)
v_mfma_f32_16x16x32_bf16 v[16:19], v[120:123], v[56:59], v[16:19]
v_mfma_f32_16x16x32_bf16 v[20:23], v[124:127], v[56:59], v[20:23]
ds_read_b64_tr_b16 v[120:121], v5 offset:20544
ds_read_b64_tr_b16 v[122:123], v5 offset:21056
ds_read_b64_tr_b16 v[124:125], v5 offset:20576
ds_read_b64_tr_b16 v[126:127], v5 offset:21088
s_waitcnt lgkmcnt(8)
v_mfma_f32_16x16x32_bf16 v[24:27], v[104:107], v[56:59], v[24:27]
v_mfma_f32_16x16x32_bf16 v[28:31], v[108:111], v[56:59], v[28:31]
ds_read_b64_tr_b16 v[104:105], v5 offset:24576
ds_read_b64_tr_b16 v[106:107], v5 offset:25088
ds_read_b64_tr_b16 v[108:109], v5 offset:24608
ds_read_b64_tr_b16 v[110:111], v5 offset:25120
s_waitcnt lgkmcnt(8)
v_mfma_f32_16x16x32_bf16 v[16:19], v[112:115], v[60:63], v[16:19]
v_mfma_f32_16x16x32_bf16 v[20:23], v[116:119], v[60:63], v[20:23]
ds_read_b64_tr_b16 v[112:113], v5 offset:24640
ds_read_b64_tr_b16 v[114:115], v5 offset:25152
ds_read_b64_tr_b16 v[116:117], v5 offset:24672
ds_read_b64_tr_b16 v[118:119], v5 offset:25184
s_waitcnt lgkmcnt(8)
v_mfma_f32_16x16x32_bf16 v[24:27], v[120:123], v[60:63], v[24:27]
v_mfma_f32_16x16x32_bf16 v[28:31], v[124:127], v[60:63], v[28:31]
ds_read_b64_tr_b16 v[120:121], v5 offset:28672
ds_read_b64_tr_b16 v[122:123], v5 offset:29184
ds_read_b64_tr_b16 v[124:125], v5 offset:28704
ds_read_b64_tr_b16 v[126:127], v5 offset:29216
s_waitcnt lgkmcnt(8)
v_mfma_f32_16x16x32_bf16 v[16:19], v[104:107], v[64:67], v[16:19]
v_mfma_f32_16x16x32_bf16 v[20:23], v[108:111], v[64:67], v[20:23]
ds_read_b64_tr_b16 v[104:105], v5 offset:28736
ds_read_b64_tr_b16 v[106:107], v5 offset:29248
ds_read_b64_tr_b16 v[108:109], v5 offset:28768
ds_read_b64_tr_b16 v[110:111], v5 offset:29280
s_waitcnt lgkmcnt(8)
v_mfma_f32_16x16x32_bf16 v[24:27], v[112:115], v[64:67], v[24:27]
v_mfma_f32_16x16x32_bf16 v[28:31], v[116:119], v[64:67], v[28:31]
s_waitcnt lgkmcnt(4)
v_mfma_f32_16x16x32_bf16 v[16:19], v[120:123], v[68:71], v[16:19]
v_mfma_f32_16x16x32_bf16 v[20:23], v[124:127], v[68:71], v[20:23]
s_waitcnt lgkmcnt(0)
v_mfma_f32_16x16x32_bf16 v[24:27], v[104:107], v[68:71], v[24:27]
v_mfma_f32_16x16x32_bf16 v[28:31], v[108:111], v[68:71], v[28:31]
s_nop 5
v_cndmask_b32 v16, v20, v16, vcc
v_cndmask_b32 v17, v21, v17, vcc
v_cndmask_b32 v18, v22, v18, vcc
v_cndmask_b32 v19, v23, v19, vcc
v_cndmask_b32 v24, v28, v24, vcc
v_cndmask_b32 v25, v29, v25, vcc
v_cndmask_b32 v26, v30, v26, vcc
v_cndmask_b32 v27, v31, v27, vcc
v_bfi_b32 v16, v14, s17, v16
v_bfi_b32 v17, v14, s18, v17
v_bfi_b32 v18, v14, s19, v18
v_bfi_b32 v19, v14, s20, v19
v_bfi_b32 v24, v14, s17, v24
v_bfi_b32 v25, v14, s18, v25
v_bfi_b32 v26, v14, s19, v26
v_bfi_b32 v27, v14, s20, v27
buffer_store_dwordx4 v[16:19], v6, s[52:55], s12 offen sc1
buffer_store_dwordx4 v[24:27], v6, s[52:55], s12 offen offset:128 sc1
s_lshl_b32 s10, s6, 14
s_lshl_b32 s11, s4, 11
s_add_u32 s10, s10, s11
s_add_u32 s10, s10, 524288
s_add_u32 s11, s10, 0x20000
s_add_u32 s12, s10, 0x40000
s_add_u32 s13, s10, 0x60000
v_lshrrev_b32 v5, 1, v4
v_add_u32 v5, 147456, v5
s_mov_b32 s14, 0
s_mov_b64 s[22:23], -1
s_mov_b64 s[24:25], -1
s_mov_b64 s[26:27], -1
s_mov_b64 s[28:29], -1
s_mov_b64 s[30:31], -1
s_mov_b64 s[32:33], -1
s_mov_b64 s[34:35], -1
s_mov_b64 s[58:59], -1
s_waitcnt vmcnt(0)
v_mov_b32 v8, 0
ds_write_b32 v12, v8 offset:104
s_cmp_ge_i32 s42, 19
s_cbranch_scc1 L_wd5
s_mov_b32 s43, 0
L_wl4:
ds_read_b32 v8, v12 offset:128
s_waitcnt lgkmcnt(0)
v_readfirstlane_b32 s42, v8
s_cmp_ge_i32 s42, 19
s_cbranch_scc1 L_wd5
s_sleep 2
s_add_u32 s43, s43, 1
s_cmp_lt_u32 s43, 2097152
s_cbranch_scc1 L_wl4
L_wd5:
L_qpoll:
s_mov_b64 exec, s[22:23]
s_cbranch_execz L_qs0
buffer_load_dwordx4 v[40:43], v4, s[52:55], s10 offen offset:0 sc1
L_qs0:
s_mov_b64 exec, s[24:25]
s_cbranch_execz L_qs1
buffer_load_dwordx4 v[44:47], v4, s[52:55], s10 offen offset:1024 sc1
L_qs1:
s_mov_b64 exec, s[26:27]
s_cbranch_execz L_qs2
buffer_load_dwordx4 v[48:51], v4, s[52:55], s11 offen offset:0 sc1
L_qs2:
s_mov_b64 exec, s[28:29]
s_cbranch_execz L_qs3
buffer_load_dwordx4 v[52:55], v4, s[52:55], s11 offen offset:1024 sc1
L_qs3:
s_mov_b64 exec, s[30:31]
s_cbranch_execz L_qs4
buffer_load_dwordx4 v[56:59], v4, s[52:55], s12 offen offset:0 sc1
L_qs4:
s_mov_b64 exec, s[32:33]
s_cbranch_execz L_qs5
buffer_load_dwordx4 v[60:63], v4, s[52:55], s12 offen offset:1024 sc1
L_qs5:
s_mov_b64 exec, s[34:35]
s_cbranch_execz L_qs6
buffer_load_dwordx4 v[64:67], v4, s[52:55], s13 offen offset:0 sc1
L_qs6:
s_mov_b64 exec, s[58:59]
s_cbranch_execz L_qs7
buffer_load_dwordx4 v[68:71], v4, s[52:55], s13 offen offset:1024 sc1
L_qs7:
s_mov_b64 exec, -1
s_waitcnt vmcnt(0)
s_mov_b64 s[56:57], 0
v_xor_b32 v72, s17, v40
v_xor_b32 v73, s18, v41
v_xor_b32 v74, s19, v42
v_xor_b32 v75, s20, v43
v_or3_b32 v8, v72, v73, v74
v_bitop3_b32 v8, v8, v75, v14 bitop3:0xa8
v_cmp_ne_u32 vcc, 0, v8
s_wqm_b64 s[22:23], vcc
s_or_b64 s[56:57], s[56:57], vcc
v_xor_b32 v76, s17, v44
v_xor_b32 v77, s18, v45
v_xor_b32 v78, s19, v46
v_xor_b32 v79, s20, v47
v_or3_b32 v8, v76, v77, v78
v_bitop3_b32 v8, v8, v79, v14 bitop3:0xa8
v_cmp_ne_u32 vcc, 0, v8
s_wqm_b64 s[24:25], vcc
s_or_b64 s[56:57], s[56:57], vcc
v_xor_b32 v80, s17, v48
v_xor_b32 v81, s18, v49
v_xor_b32 v82, s19, v50
v_xor_b32 v83, s20, v51
v_or3_b32 v8, v80, v81, v82
v_bitop3_b32 v8, v8, v83, v14 bitop3:0xa8
v_cmp_ne_u32 vcc, 0, v8
s_wqm_b64 s[26:27], vcc
s_or_b64 s[56:57], s[56:57], vcc
v_xor_b32 v84, s17, v52
v_xor_b32 v85, s18, v53
v_xor_b32 v86, s19, v54
v_xor_b32 v87, s20, v55
v_or3_b32 v8, v84, v85, v86
v_bitop3_b32 v8, v8, v87, v14 bitop3:0xa8
v_cmp_ne_u32 vcc, 0, v8
s_wqm_b64 s[28:29], vcc
s_or_b64 s[56:57], s[56:57], vcc
v_xor_b32 v88, s17, v56
v_xor_b32 v89, s18, v57
v_xor_b32 v90, s19, v58
v_xor_b32 v91, s20, v59
v_or3_b32 v8, v88, v89, v90
v_bitop3_b32 v8, v8, v91, v14 bitop3:0xa8
v_cmp_ne_u32 vcc, 0, v8
s_wqm_b64 s[30:31], vcc
s_or_b64 s[56:57], s[56:57], vcc
v_xor_b32 v92, s17, v60
v_xor_b32 v93, s18, v61
v_xor_b32 v94, s19, v62
v_xor_b32 v95, s20, v63
v_or3_b32 v8, v92, v93, v94
v_bitop3_b32 v8, v8, v95, v14 bitop3:0xa8
v_cmp_ne_u32 vcc, 0, v8
s_wqm_b64 s[32:33], vcc
s_or_b64 s[56:57], s[56:57], vcc
v_xor_b32 v96, s17, v64
v_xor_b32 v97, s18, v65
v_xor_b32 v98, s19, v66
v_xor_b32 v99, s20, v67
v_or3_b32 v8, v96, v97, v98
v_bitop3_b32 v8, v8, v99, v14 bitop3:0xa8
v_cmp_ne_u32 vcc, 0, v8
s_wqm_b64 s[34:35], vcc
s_or_b64 s[56:57], s[56:57], vcc
v_xor_b32 v100, s17, v68
v_xor_b32 v101, s18, v69
v_xor_b32 v102, s19, v70
v_xor_b32 v103, s20, v71
v_or3_b32 v8, v100, v101, v102
v_bitop3_b32 v8, v8, v103, v14 bitop3:0xa8
v_cmp_ne_u32 vcc, 0, v8
s_wqm_b64 s[58:59], vcc
s_or_b64 s[56:57], s[56:57], vcc
s_cbranch_scc0 L_qgot
s_sleep 8
s_add_u32 s14, s14, 1
s_cmp_lt_u32 s14, 262144
s_cbranch_scc1 L_qpoll
L_qgot:
v_add_f32 v72, v72, v80
v_add_f32 v73, v73, v81
v_add_f32 v74, v74, v82
v_add_f32 v75, v75, v83
v_cvt_pk_bf16_f32 v72, v72, v73
v_cvt_pk_bf16_f32 v73, v74, v75
ds_write_b64 v5, v[72:73] offset:0
v_add_f32 v76, v76, v84
v_add_f32 v77, v77, v85
v_add_f32 v78, v78, v86
v_add_f32 v79, v79, v87
v_cvt_pk_bf16_f32 v76, v76, v77
v_cvt_pk_bf16_f32 v77, v78, v79
ds_write_b64 v5, v[76:77] offset:512
v_add_f32 v88, v88, v96
v_add_f32 v89, v89, v97
v_add_f32 v90, v90, v98
v_add_f32 v91, v91, v99
v_cvt_pk_bf16_f32 v88, v88, v89
v_cvt_pk_bf16_f32 v89, v90, v91
ds_write_b64 v5, v[88:89] offset:1024
v_add_f32 v92, v92, v100
v_add_f32 v93, v93, v101
v_add_f32 v94, v94, v102
v_add_f32 v95, v95, v103
v_cvt_pk_bf16_f32 v92, v92, v93
v_cvt_pk_bf16_f32 v93, v94, v95
ds_write_b64 v5, v[92:93] offset:1536
v_mov_b32 v8, 1
v_mov_b32 v9, s16
s_waitcnt lgkmcnt(0)
ds_write_b64 v12, v[8:9] offset:120
s_lshl_b32 s60, s4, 9
s_add_u32 s60, s60, 4096
s_lshl_b32 s61, s5, 2
v_mov_b32 v5, s61
v_lshlrev_b32 v6, 2, v0
v_and_b32 v6, 127, v6
s_and_b32 s62, s16, 0xffffff00
v_mov_b32 v11, 0x100
s_mov_b32 s43, 0
L_mn6:
ds_read_b32 v8, v12 offset:128
s_waitcnt lgkmcnt(0)
v_or_b32 v9, s62, v8
v_readfirstlane_b32 s42, v8
s_mov_b64 exec, 1
buffer_store_dword v9, v5, s[52:55], s60 offen
s_mov_b64 exec, -1
buffer_load_dword v10, v6, s[52:55], s60 offen sc1
v_add_u32 v8, 0, v8
s_waitcnt vmcnt(0)
v_xor_b32 v10, s62, v10
v_cmp_lt_u32 s[22:23], v10, v11
v_cmp_gt_i32 vcc, v10, v8
s_mov_b32 s24, s22
s_and_b32 s22, s22, vcc_lo
s_bcnt1_i32_b32 s22, s22
s_cmp_ge_u32 s22, 16
s_cselect_b32 s22, 1, 0
v_mov_b32 v8, s22
v_mov_b32 v9, s24
ds_write_b64 v12, v[8:9] offset:104
s_sleep 4
s_add_u32 s43, s43, 1
s_cmp_lt_u32 s43, 262144
s_cbranch_scc0 L_mn6x
s_cmp_lt_i32 s42, 152
s_cbranch_scc1 L_mn6
L_mn6x:
s_waitcnt lgkmcnt(0)
s_barrier
s_branch L_tail
L_attn:
s_sub_u32 s8, s3, 2
s_cmp_ge_u32 s8, 8
s_cselect_b32 s11, 2, 8
s_cselect_b32 s10, 56, 0
s_cselect_b32 s44, 0, 32
s_add_u32 s10, s10, s8
v_and_b32 v1, 3, v0
v_bfe_u32 v2, v0, 2, 2
v_lshl_add_u32 v1, v1, 2, v2
v_lshrrev_b32 v2, 4, v0
v_lshlrev_b32 v2, 2, v2
v_xor_b32 v2, v2, v1
v_lshlrev_b32 v2, 4, v2
v_lshl_add_u32 v47, v1, 8, v2
v_and_b32 v8, 1, v0
v_cmp_eq_u32 vcc, 0, v8
v_mov_b32 v9, 0x0c0c0100
v_mov_b32 v10, 0x01000c0c
v_mov_b32 v11, 0x0c0c0302
v_mov_b32 v12, 0x03020c0c
v_cndmask_b32 v9, v10, v9, vcc
v_cndmask_b32 v11, v12, v11, vcc
v_and_b32 v8, 2, v0
v_cmp_eq_u32 vcc, 0, v8
v_mov_b32 v10, 0x0c0c0c0c
s_nop 0
v_cndmask_b32 v3, v10, v9, vcc
v_cndmask_b32 v4, v9, v10, vcc
v_cndmask_b32 v5, v10, v11, vcc
v_cndmask_b32 v6, v11, v10, vcc
s_cmp_ge_u32 s8, 8
s_cselect_b32 s15, 0, 1024
s_add_u32 s15, s15, 147456
v_bfe_u32 v1, v0, 2, 2
v_lshlrev_b32 v1, 8, v1
v_lshrrev_b32 v8, 4, v0
v_lshl_add_u32 v1, v8, 6, v1
v_add_u32 v1, s15, v1
s_mov_b32 s66, 0x3db504f3
s_mov_b32 s67, 0x3fb8aa3b
s_mov_b32 s42, 0
v_mov_b32 v44, 152000
v_mov_b32 v46, 1
s_waitcnt lgkmcnt(0)
s_add_u32 s9, s10, 9
s_mul_i32 s13, s10, 205
s_lshr_b32 s13, s13, 12
s_mul_i32 s12, s13, 20
s_sub_u32 s12, s10, s12
s_lshl_b32 s45, s12, 12
s_add_u32 s45, s45, 65536
s_and_b32 s46, s12, 28
s_add_u32 s10, s10, s11
v_add_u32 v40, s45, v47
v_xor_b32 v41, 16, v40
v_xor_b32 v42, 32, v40
v_xor_b32 v43, 48, v40
s_cmp_ge_i32 s42, s9
s_cbranch_scc1 L_wd8
s_mov_b32 s43, 0
L_wl7:
ds_read_b32 v8, v44 offset:128
s_waitcnt lgkmcnt(0)
v_readfirstlane_b32 s42, v8
s_cmp_ge_i32 s42, s9
s_cbranch_scc1 L_wd8
s_sleep 1
s_add_u32 s43, s43, 1
s_cmp_lt_u32 s43, 2097152
s_cbranch_scc1 L_wl7
L_wd8:
ds_read_b128 v[80:83], v40
ds_read_b128 v[84:87], v41
ds_read_b128 v[88:91], v42
ds_read_b128 v[92:95], v43
s_waitcnt lgkmcnt(0)
s_mov_b64 exec, 1
v_add_u32 v45, s46, v44
ds_add_u32 v45, v46
s_mov_b64 exec, -1
s_add_u32 s9, s10, 9
s_mul_i32 s13, s10, 205
s_lshr_b32 s13, s13, 12
s_mul_i32 s12, s13, 20
s_sub_u32 s12, s10, s12
s_lshl_b32 s45, s12, 12
s_add_u32 s45, s45, 65536
s_and_b32 s46, s12, 28
s_add_u32 s10, s10, s11
v_add_u32 v40, s45, v47
v_xor_b32 v41, 16, v40
v_xor_b32 v42, 32, v40
v_xor_b32 v43, 48, v40
s_cmp_ge_i32 s42, s9
s_cbranch_scc1 L_wd10
s_mov_b32 s43, 0
L_wl9:
ds_read_b32 v8, v44 offset:128
s_waitcnt lgkmcnt(0)
v_readfirstlane_b32 s42, v8
s_cmp_ge_i32 s42, s9
s_cbranch_scc1 L_wd10
s_sleep 1
s_add_u32 s43, s43, 1
s_cmp_lt_u32 s43, 2097152
s_cbranch_scc1 L_wl9
L_wd10:
ds_read_b128 v[96:99], v40
ds_read_b128 v[100:103], v41
ds_read_b128 v[104:107], v42
ds_read_b128 v[108:111], v43
s_waitcnt lgkmcnt(0)
s_mov_b64 exec, 1
v_add_u32 v45, s46, v44
ds_add_u32 v45, v46
s_mov_b64 exec, -1
s_add_u32 s9, s10, 9
s_mul_i32 s13, s10, 205
s_lshr_b32 s13, s13, 12
s_mul_i32 s12, s13, 20
s_sub_u32 s12, s10, s12
s_lshl_b32 s45, s12, 12
s_add_u32 s45, s45, 65536
s_and_b32 s46, s12, 28
s_add_u32 s10, s10, s11
v_add_u32 v40, s45, v47
v_xor_b32 v41, 16, v40
v_xor_b32 v42, 32, v40
v_xor_b32 v43, 48, v40
s_cmp_ge_i32 s42, s9
s_cbranch_scc1 L_wd12
s_mov_b32 s43, 0
L_wl11:
ds_read_b32 v8, v44 offset:128
s_waitcnt lgkmcnt(0)
v_readfirstlane_b32 s42, v8
s_cmp_ge_i32 s42, s9
s_cbranch_scc1 L_wd12
s_sleep 1
s_add_u32 s43, s43, 1
s_cmp_lt_u32 s43, 2097152
s_cbranch_scc1 L_wl11
L_wd12:
ds_read_b128 v[112:115], v40
ds_read_b128 v[116:119], v41
ds_read_b128 v[120:123], v42
ds_read_b128 v[124:127], v43
s_waitcnt lgkmcnt(0)
s_mov_b64 exec, 1
v_add_u32 v45, s46, v44
ds_add_u32 v45, v46
s_mov_b64 exec, -1
s_add_u32 s9, s10, 9
s_mul_i32 s13, s10, 205
s_lshr_b32 s13, s13, 12
s_mul_i32 s12, s13, 20
s_sub_u32 s12, s10, s12
s_lshl_b32 s45, s12, 12
s_add_u32 s45, s45, 65536
s_and_b32 s46, s12, 28
s_add_u32 s10, s10, s11
v_add_u32 v40, s45, v47
v_xor_b32 v41, 16, v40
v_xor_b32 v42, 32, v40
v_xor_b32 v43, 48, v40
s_cmp_ge_i32 s42, s9
s_cbranch_scc1 L_wd14
s_mov_b32 s43, 0
L_wl13:
ds_read_b32 v8, v44 offset:128
s_waitcnt lgkmcnt(0)
v_readfirstlane_b32 s42, v8
s_cmp_ge_i32 s42, s9
s_cbranch_scc1 L_wd14
s_sleep 1
s_add_u32 s43, s43, 1
s_cmp_lt_u32 s43, 2097152
s_cbranch_scc1 L_wl13
L_wd14:
ds_read_b128 v[128:131], v40
ds_read_b128 v[132:135], v41
ds_read_b128 v[136:139], v42
ds_read_b128 v[140:143], v43
s_waitcnt lgkmcnt(0)
s_mov_b64 exec, 1
v_add_u32 v45, s46, v44
ds_add_u32 v45, v46
s_mov_b64 exec, -1
s_mov_b32 s14, 0
L_qw:
ds_read_b64 v[8:9], v44 offset:120
s_waitcnt lgkmcnt(0)
v_readfirstlane_b32 s15, v8
v_readfirstlane_b32 s16, v9
s_cmp_lg_u32 s15, 0
s_cbranch_scc1 L_qw2
s_sleep 2
s_add_u32 s14, s14, 1
s_cmp_lt_u32 s14, 2097152
s_cbranch_scc1 L_qw
L_qw2:
ds_read_b128 v[24:27], v1 offset:0
ds_read_b128 v[28:31], v1 offset:16
ds_read_b128 v[32:35], v1 offset:32
ds_read_b128 v[36:39], v1 offset:48
s_waitcnt lgkmcnt(0)
v_mfma_f32_16x16x32_bf16 v[48:51], v[80:83], v[24:27], 0
v_mfma_f32_16x16x32_bf16 v[48:51], v[84:87], v[28:31], v[48:51]
v_mfma_f32_16x16x32_bf16 v[48:51], v[88:91], v[32:35], v[48:51]
v_mfma_f32_16x16x32_bf16 v[48:51], v[92:95], v[36:39], v[48:51]
v_mfma_f32_16x16x32_bf16 v[52:55], v[96:99], v[24:27], 0
v_mfma_f32_16x16x32_bf16 v[52:55], v[100:103], v[28:31], v[52:55]
v_mfma_f32_16x16x32_bf16 v[52:55], v[104:107], v[32:35], v[52:55]
v_mfma_f32_16x16x32_bf16 v[52:55], v[108:111], v[36:39], v[52:55]
v_mfma_f32_16x16x32_bf16 v[56:59], v[112:115], v[24:27], 0
v_mfma_f32_16x16x32_bf16 v[56:59], v[116:119], v[28:31], v[56:59]
v_mfma_f32_16x16x32_bf16 v[56:59], v[120:123], v[32:35], v[56:59]
v_mfma_f32_16x16x32_bf16 v[56:59], v[124:127], v[36:39], v[56:59]
v_mfma_f32_16x16x32_bf16 v[60:63], v[128:131], v[24:27], 0
v_mfma_f32_16x16x32_bf16 v[60:63], v[132:135], v[28:31], v[60:63]
v_mfma_f32_16x16x32_bf16 v[60:63], v[136:139], v[32:35], v[60:63]
v_mfma_f32_16x16x32_bf16 v[60:63], v[140:143], v[36:39], v[60:63]
s_nop 7
v_cvt_pk_bf16_f32 v8, v48, v49
v_lshlrev_b32 v48, 16, v8
v_and_b32 v49, 0xffff0000, v8
v_mul_f32 v48, s66, v48
v_mul_f32 v49, s66, v49
v_cvt_pk_bf16_f32 v8, v48, v49
v_lshlrev_b32 v48, 16, v8
v_and_b32 v49, 0xffff0000, v8
v_max_f32 v7, v48, v49
v_cvt_pk_bf16_f32 v8, v50, v51
v_lshlrev_b32 v50, 16, v8
v_and_b32 v51, 0xffff0000, v8
v_mul_f32 v50, s66, v50
v_mul_f32 v51, s66, v51
v_cvt_pk_bf16_f32 v8, v50, v51
v_lshlrev_b32 v50, 16, v8
v_and_b32 v51, 0xffff0000, v8
v_max3_f32 v7, v50, v51, v7
v_cvt_pk_bf16_f32 v8, v52, v53
v_lshlrev_b32 v52, 16, v8
v_and_b32 v53, 0xffff0000, v8
v_mul_f32 v52, s66, v52
v_mul_f32 v53, s66, v53
v_cvt_pk_bf16_f32 v8, v52, v53
v_lshlrev_b32 v52, 16, v8
v_and_b32 v53, 0xffff0000, v8
v_max3_f32 v7, v52, v53, v7
v_cvt_pk_bf16_f32 v8, v54, v55
v_lshlrev_b32 v54, 16, v8
v_and_b32 v55, 0xffff0000, v8
v_mul_f32 v54, s66, v54
v_mul_f32 v55, s66, v55
v_cvt_pk_bf16_f32 v8, v54, v55
v_lshlrev_b32 v54, 16, v8
v_and_b32 v55, 0xffff0000, v8
v_max3_f32 v7, v54, v55, v7
v_cvt_pk_bf16_f32 v8, v56, v57
v_lshlrev_b32 v56, 16, v8
v_and_b32 v57, 0xffff0000, v8
v_mul_f32 v56, s66, v56
v_mul_f32 v57, s66, v57
v_cvt_pk_bf16_f32 v8, v56, v57
v_lshlrev_b32 v56, 16, v8
v_and_b32 v57, 0xffff0000, v8
v_max3_f32 v7, v56, v57, v7
v_cvt_pk_bf16_f32 v8, v58, v59
v_lshlrev_b32 v58, 16, v8
v_and_b32 v59, 0xffff0000, v8
v_mul_f32 v58, s66, v58
v_mul_f32 v59, s66, v59
v_cvt_pk_bf16_f32 v8, v58, v59
v_lshlrev_b32 v58, 16, v8
v_and_b32 v59, 0xffff0000, v8
v_max3_f32 v7, v58, v59, v7
v_cvt_pk_bf16_f32 v8, v60, v61
v_lshlrev_b32 v60, 16, v8
v_and_b32 v61, 0xffff0000, v8
v_mul_f32 v60, s66, v60
v_mul_f32 v61, s66, v61
v_cvt_pk_bf16_f32 v8, v60, v61
v_lshlrev_b32 v60, 16, v8
v_and_b32 v61, 0xffff0000, v8
v_max3_f32 v7, v60, v61, v7
v_cvt_pk_bf16_f32 v8, v62, v63
v_lshlrev_b32 v62, 16, v8
v_and_b32 v63, 0xffff0000, v8
v_mul_f32 v62, s66, v62
v_mul_f32 v63, s66, v63
v_cvt_pk_bf16_f32 v8, v62, v63
v_lshlrev_b32 v62, 16, v8
v_and_b32 v63, 0xffff0000, v8
v_max3_f32 v7, v62, v63, v7
s_add_u32 s9, s10, 9
s_mul_i32 s13, s10, 205
s_lshr_b32 s13, s13, 12
s_mul_i32 s12, s13, 20
s_sub_u32 s12, s10, s12
s_lshl_b32 s45, s12, 12
s_add_u32 s45, s45, 65536
s_and_b32 s46, s12, 28
s_add_u32 s10, s10, s11
v_add_u32 v40, s45, v47
v_xor_b32 v41, 16, v40
v_xor_b32 v42, 32, v40
v_xor_b32 v43, 48, v40
s_cmp_ge_i32 s42, s9
s_cbranch_scc1 L_wd16
s_mov_b32 s43, 0
L_wl15:
ds_read_b32 v8, v44 offset:128
s_waitcnt lgkmcnt(0)
v_readfirstlane_b32 s42, v8
s_cmp_ge_i32 s42, s9
s_cbranch_scc1 L_wd16
s_sleep 1
s_add_u32 s43, s43, 1
s_cmp_lt_u32 s43, 2097152
s_cbranch_scc1 L_wl15
L_wd16:
ds_read_b128 v[80:83], v40
ds_read_b128 v[84:87], v41
ds_read_b128 v[88:91], v42
ds_read_b128 v[92:95], v43
s_waitcnt lgkmcnt(0)
s_mov_b64 exec, 1
v_add_u32 v45, s46, v44
ds_add_u32 v45, v46
s_mov_b64 exec, -1
v_mfma_f32_16x16x32_bf16 v[64:67], v[80:83], v[24:27], 0
v_mfma_f32_16x16x32_bf16 v[64:67], v[84:87], v[28:31], v[64:67]
v_mfma_f32_16x16x32_bf16 v[64:67], v[88:91], v[32:35], v[64:67]
v_mfma_f32_16x16x32_bf16 v[64:67], v[92:95], v[36:39], v[64:67]
s_nop 7
v_cvt_pk_bf16_f32 v8, v64, v65
v_lshlrev_b32 v64, 16, v8
v_and_b32 v65, 0xffff0000, v8
v_mul_f32 v64, s66, v64
v_mul_f32 v65, s66, v65
v_cvt_pk_bf16_f32 v8, v64, v65
v_lshlrev_b32 v64, 16, v8
v_and_b32 v65, 0xffff0000, v8
v_max3_f32 v7, v64, v65, v7
v_cvt_pk_bf16_f32 v8, v66, v67
v_lshlrev_b32 v66, 16, v8
v_and_b32 v67, 0xffff0000, v8
v_mul_f32 v66, s66, v66
v_mul_f32 v67, s66, v67
v_cvt_pk_bf16_f32 v8, v66, v67
v_lshlrev_b32 v66, 16, v8
v_and_b32 v67, 0xffff0000, v8
v_max3_f32 v7, v66, v67, v7
s_add_u32 s9, s10, 9
s_mul_i32 s13, s10, 205
s_lshr_b32 s13, s13, 12
s_mul_i32 s12, s13, 20
s_sub_u32 s12, s10, s12
s_lshl_b32 s45, s12, 12
s_add_u32 s45, s45, 65536
s_and_b32 s46, s12, 28
s_add_u32 s10, s10, s11
v_add_u32 v40, s45, v47
v_xor_b32 v41, 16, v40
v_xor_b32 v42, 32, v40
v_xor_b32 v43, 48, v40
s_cmp_ge_i32 s42, s9
s_cbranch_scc1 L_wd18
s_mov_b32 s43, 0
L_wl17:
ds_read_b32 v8, v44 offset:128
s_waitcnt lgkmcnt(0)
v_readfirstlane_b32 s42, v8
s_cmp_ge_i32 s42, s9
s_cbranch_scc1 L_wd18
s_sleep 1
s_add_u32 s43, s43, 1
s_cmp_lt_u32 s43, 2097152
s_cbranch_scc1 L_wl17
L_wd18:
ds_read_b128 v[96:99], v40
ds_read_b128 v[100:103], v41
ds_read_b128 v[104:107], v42
ds_read_b128 v[108:111], v43
s_waitcnt lgkmcnt(0)
s_mov_b64 exec, 1
v_add_u32 v45, s46, v44
ds_add_u32 v45, v46
s_mov_b64 exec, -1
v_mfma_f32_16x16x32_bf16 v[68:71], v[96:99], v[24:27], 0
v_mfma_f32_16x16x32_bf16 v[68:71], v[100:103], v[28:31], v[68:71]
v_mfma_f32_16x16x32_bf16 v[68:71], v[104:107], v[32:35], v[68:71]
v_mfma_f32_16x16x32_bf16 v[68:71], v[108:111], v[36:39], v[68:71]
s_nop 7
v_cvt_pk_bf16_f32 v8, v68, v69
v_lshlrev_b32 v68, 16, v8
v_and_b32 v69, 0xffff0000, v8
v_mul_f32 v68, s66, v68
v_mul_f32 v69, s66, v69
v_cvt_pk_bf16_f32 v8, v68, v69
v_lshlrev_b32 v68, 16, v8
v_and_b32 v69, 0xffff0000, v8
v_max3_f32 v7, v68, v69, v7
v_cvt_pk_bf16_f32 v8, v70, v71
v_lshlrev_b32 v70, 16, v8
v_and_b32 v71, 0xffff0000, v8
v_mul_f32 v70, s66, v70
v_mul_f32 v71, s66, v71
v_cvt_pk_bf16_f32 v8, v70, v71
v_lshlrev_b32 v70, 16, v8
v_and_b32 v71, 0xffff0000, v8
v_max3_f32 v7, v70, v71, v7
s_add_u32 s9, s10, 9
s_mul_i32 s13, s10, 205
s_lshr_b32 s13, s13, 12
s_mul_i32 s12, s13, 20
s_sub_u32 s12, s10, s12
s_lshl_b32 s45, s12, 12
s_add_u32 s45, s45, 65536
s_and_b32 s46, s12, 28
s_add_u32 s10, s10, s11
v_add_u32 v40, s45, v47
v_xor_b32 v41, 16, v40
v_xor_b32 v42, 32, v40
v_xor_b32 v43, 48, v40
s_cmp_ge_i32 s42, s9
s_cbranch_scc1 L_wd20
s_mov_b32 s43, 0
L_wl19:
ds_read_b32 v8, v44 offset:128
s_waitcnt lgkmcnt(0)
v_readfirstlane_b32 s42, v8
s_cmp_ge_i32 s42, s9
s_cbranch_scc1 L_wd20
s_sleep 1
s_add_u32 s43, s43, 1
s_cmp_lt_u32 s43, 2097152
s_cbranch_scc1 L_wl19
L_wd20:
ds_read_b128 v[112:115], v40
ds_read_b128 v[116:119], v41
ds_read_b128 v[120:123], v42
ds_read_b128 v[124:127], v43
s_waitcnt lgkmcnt(0)
s_mov_b64 exec, 1
v_add_u32 v45, s46, v44
ds_add_u32 v45, v46
s_mov_b64 exec, -1
v_mfma_f32_16x16x32_bf16 v[72:75], v[112:115], v[24:27], 0
v_mfma_f32_16x16x32_bf16 v[72:75], v[116:119], v[28:31], v[72:75]
v_mfma_f32_16x16x32_bf16 v[72:75], v[120:123], v[32:35], v[72:75]
v_mfma_f32_16x16x32_bf16 v[72:75], v[124:127], v[36:39], v[72:75]
s_nop 7
v_cvt_pk_bf16_f32 v8, v72, v73
v_lshlrev_b32 v72, 16, v8
v_and_b32 v73, 0xffff0000, v8
v_mul_f32 v72, s66, v72
v_mul_f32 v73, s66, v73
v_cvt_pk_bf16_f32 v8, v72, v73
v_lshlrev_b32 v72, 16, v8
v_and_b32 v73, 0xffff0000, v8
v_max3_f32 v7, v72, v73, v7
v_cvt_pk_bf16_f32 v8, v74, v75
v_lshlrev_b32 v74, 16, v8
v_and_b32 v75, 0xffff0000, v8
v_mul_f32 v74, s66, v74
v_mul_f32 v75, s66, v75
v_cvt_pk_bf16_f32 v8, v74, v75
v_lshlrev_b32 v74, 16, v8
v_and_b32 v75, 0xffff0000, v8
v_max3_f32 v7, v74, v75, v7
s_add_u32 s9, s10, 9
s_mul_i32 s13, s10, 205
s_lshr_b32 s13, s13, 12
s_mul_i32 s12, s13, 20
s_sub_u32 s12, s10, s12
s_lshl_b32 s45, s12, 12
s_add_u32 s45, s45, 65536
s_and_b32 s46, s12, 28
s_add_u32 s10, s10, s11
v_add_u32 v40, s45, v47
v_xor_b32 v41, 16, v40
v_xor_b32 v42, 32, v40
v_xor_b32 v43, 48, v40
s_cmp_ge_i32 s42, s9
s_cbranch_scc1 L_wd22
s_mov_b32 s43, 0
L_wl21:
ds_read_b32 v8, v44 offset:128
s_waitcnt lgkmcnt(0)
v_readfirstlane_b32 s42, v8
s_cmp_ge_i32 s42, s9
s_cbranch_scc1 L_wd22
s_sleep 1
s_add_u32 s43, s43, 1
s_cmp_lt_u32 s43, 2097152
s_cbranch_scc1 L_wl21
L_wd22:
ds_read_b128 v[128:131], v40
ds_read_b128 v[132:135], v41
ds_read_b128 v[136:139], v42
ds_read_b128 v[140:143], v43
s_waitcnt lgkmcnt(0)
s_mov_b64 exec, 1
v_add_u32 v45, s46, v44
ds_add_u32 v45, v46
s_mov_b64 exec, -1
v_mfma_f32_16x16x32_bf16 v[76:79], v[128:131], v[24:27], 0
v_mfma_f32_16x16x32_bf16 v[76:79], v[132:135], v[28:31], v[76:79]
v_mfma_f32_16x16x32_bf16 v[76:79], v[136:139], v[32:35], v[76:79]
v_mfma_f32_16x16x32_bf16 v[76:79], v[140:143], v[36:39], v[76:79]
s_nop 7
v_cvt_pk_bf16_f32 v8, v76, v77
v_lshlrev_b32 v76, 16, v8
v_and_b32 v77, 0xffff0000, v8
v_mul_f32 v76, s66, v76
v_mul_f32 v77, s66, v77
v_cvt_pk_bf16_f32 v8, v76, v77
v_lshlrev_b32 v76, 16, v8
v_and_b32 v77, 0xffff0000, v8
v_max3_f32 v7, v76, v77, v7
v_cvt_pk_bf16_f32 v8, v78, v79
v_lshlrev_b32 v78, 16, v8
v_and_b32 v79, 0xffff0000, v8
v_mul_f32 v78, s66, v78
v_mul_f32 v79, s66, v79
v_cvt_pk_bf16_f32 v8, v78, v79
v_lshlrev_b32 v78, 16, v8
v_and_b32 v79, 0xffff0000, v8
v_max3_f32 v7, v78, v79, v7
v_mov_b32 v8, v7
s_nop 1
v_permlane32_swap_b32 v8, v7
v_max_f32 v7, v8, v7
v_mov_b32 v8, v7
s_nop 1
v_permlane16_swap_b32 v8, v7
v_max_f32 v7, v8, v7
v_mul_f32 v10, s67, v7
v_mov_b32 v16, 0
v_mov_b32 v17, 0
v_mov_b32 v18, 0
v_mov_b32 v19, 0
v_mov_b32 v20, 0
v_mov_b32 v21, 0
v_mov_b32 v22, 0
v_mov_b32 v23, 0
v_mov_b32 v11, 0
v_fma_f32 v48, v48, s67, -v10
v_fma_f32 v49, v49, s67, -v10
v_fma_f32 v50, v50, s67, -v10
v_fma_f32 v51, v51, s67, -v10
v_exp_f32 v48, v48
v_exp_f32 v49, v49
v_exp_f32 v50, v50
v_exp_f32 v51, v51
v_add_f32 v11, v11, v48
v_add_f32 v11, v11, v49
v_add_f32 v11, v11, v50
v_add_f32 v11, v11, v51
v_cvt_pk_bf16_f32 v24, v48, v49
v_cvt_pk_bf16_f32 v25, v50, v51
v_fma_f32 v52, v52, s67, -v10
v_fma_f32 v53, v53, s67, -v10
v_fma_f32 v54, v54, s67, -v10
v_fma_f32 v55, v55, s67, -v10
v_exp_f32 v52, v52
v_exp_f32 v53, v53
v_exp_f32 v54, v54
v_exp_f32 v55, v55
v_add_f32 v11, v11, v52
v_add_f32 v11, v11, v53
v_add_f32 v11, v11, v54
v_add_f32 v11, v11, v55
v_cvt_pk_bf16_f32 v26, v52, v53
v_cvt_pk_bf16_f32 v27, v54, v55
v_fma_f32 v56, v56, s67, -v10
v_fma_f32 v57, v57, s67, -v10
v_fma_f32 v58, v58, s67, -v10
v_fma_f32 v59, v59, s67, -v10
v_exp_f32 v56, v56
v_exp_f32 v57, v57
v_exp_f32 v58, v58
v_exp_f32 v59, v59
v_add_f32 v11, v11, v56
v_add_f32 v11, v11, v57
v_add_f32 v11, v11, v58
v_add_f32 v11, v11, v59
v_cvt_pk_bf16_f32 v28, v56, v57
v_cvt_pk_bf16_f32 v29, v58, v59
v_fma_f32 v60, v60, s67, -v10
v_fma_f32 v61, v61, s67, -v10
v_fma_f32 v62, v62, s67, -v10
v_fma_f32 v63, v63, s67, -v10
v_exp_f32 v60, v60
v_exp_f32 v61, v61
v_exp_f32 v62, v62
v_exp_f32 v63, v63
v_add_f32 v11, v11, v60
v_add_f32 v11, v11, v61
v_add_f32 v11, v11, v62
v_add_f32 v11, v11, v63
v_cvt_pk_bf16_f32 v30, v60, v61
v_cvt_pk_bf16_f32 v31, v62, v63
v_fma_f32 v64, v64, s67, -v10
v_fma_f32 v65, v65, s67, -v10
v_fma_f32 v66, v66, s67, -v10
v_fma_f32 v67, v67, s67, -v10
v_exp_f32 v64, v64
v_exp_f32 v65, v65
v_exp_f32 v66, v66
v_exp_f32 v67, v67
v_add_f32 v11, v11, v64
v_add_f32 v11, v11, v65
v_add_f32 v11, v11, v66
v_add_f32 v11, v11, v67
v_cvt_pk_bf16_f32 v32, v64, v65
v_cvt_pk_bf16_f32 v33, v66, v67
v_fma_f32 v68, v68, s67, -v10
v_fma_f32 v69, v69, s67, -v10
v_fma_f32 v70, v70, s67, -v10
v_fma_f32 v71, v71, s67, -v10
v_exp_f32 v68, v68
v_exp_f32 v69, v69
v_exp_f32 v70, v70
v_exp_f32 v71, v71
v_add_f32 v11, v11, v68
v_add_f32 v11, v11, v69
v_add_f32 v11, v11, v70
v_add_f32 v11, v11, v71
v_cvt_pk_bf16_f32 v34, v68, v69
v_cvt_pk_bf16_f32 v35, v70, v71
v_fma_f32 v72, v72, s67, -v10
v_fma_f32 v73, v73, s67, -v10
v_fma_f32 v74, v74, s67, -v10
v_fma_f32 v75, v75, s67, -v10
v_exp_f32 v72, v72
v_exp_f32 v73, v73
v_exp_f32 v74, v74
v_exp_f32 v75, v75
v_add_f32 v11, v11, v72
v_add_f32 v11, v11, v73
v_add_f32 v11, v11, v74
v_add_f32 v11, v11, v75
v_cvt_pk_bf16_f32 v36, v72, v73
v_cvt_pk_bf16_f32 v37, v74, v75
v_fma_f32 v76, v76, s67, -v10
v_fma_f32 v77, v77, s67, -v10
v_fma_f32 v78, v78, s67, -v10
v_fma_f32 v79, v79, s67, -v10
v_exp_f32 v76, v76
v_exp_f32 v77, v77
v_exp_f32 v78, v78
v_exp_f32 v79, v79
v_add_f32 v11, v11, v76
v_add_f32 v11, v11, v77
v_add_f32 v11, v11, v78
v_add_f32 v11, v11, v79
v_cvt_pk_bf16_f32 v38, v76, v77
v_cvt_pk_bf16_f32 v39, v78, v79
v_mov_b32 v8, v11
s_nop 1
v_permlane32_swap_b32 v8, v11
v_add_f32 v11, v8, v11
v_mov_b32 v8, v11
s_nop 1
v_permlane16_swap_b32 v8, v11
v_add_f32 v11, v8, v11
s_lshl_b32 s15, s8, 3
s_add_u32 s15, s15, 149504
v_bfe_u32 v12, v0, 2, 2
v_mul_u32_u24 v12, 80, v12
v_add_u32 v12, s15, v12
ds_write_b64 v12, v[10:11]
s_add_u32 s10, s10, s44
s_lshl_b32 s15, s8, 11
s_add_u32 s15, s15, 0
v_lshl_add_u32 v13, v0, 4, s15
s_add_u32 s9, s10, 9
s_mul_i32 s13, s10, 205
s_lshr_b32 s13, s13, 12
s_mul_i32 s12, s13, 20
s_sub_u32 s12, s10, s12
s_lshl_b32 s45, s12, 12
s_add_u32 s45, s45, 65536
s_and_b32 s46, s12, 28
s_add_u32 s10, s10, s11
v_lshl_add_u32 v2, v0, 4, s45
v_perm_b32 v48, v24, v24, v3
v_perm_b32 v49, v24, v24, v4
v_perm_b32 v50, v24, v24, v5
v_perm_b32 v51, v24, v24, v6
v_perm_b32 v52, v25, v25, v3
v_perm_b32 v53, v25, v25, v4
v_perm_b32 v54, v25, v25, v5
v_perm_b32 v55, v25, v25, v6
s_cmp_ge_i32 s42, s9
s_cbranch_scc1 L_wd24
s_mov_b32 s43, 0
L_wl23:
ds_read_b32 v8, v44 offset:128
s_waitcnt lgkmcnt(0)
v_readfirstlane_b32 s42, v8
s_cmp_ge_i32 s42, s9
s_cbranch_scc1 L_wd24
s_sleep 1
s_add_u32 s43, s43, 1
s_cmp_lt_u32 s43, 2097152
s_cbranch_scc1 L_wl23
L_wd24:
ds_read_b128 v[80:83], v2 offset:0
ds_read_b128 v[84:87], v2 offset:1024
ds_read_b128 v[88:91], v2 offset:2048
ds_read_b128 v[92:95], v2 offset:3072
s_waitcnt lgkmcnt(3)
v_mfma_f32_16x16x16_bf16 v[16:19], v[80:81], v[48:49], v[16:19]
v_mfma_f32_16x16x16_bf16 v[20:23], v[82:83], v[48:49], v[20:23]
s_waitcnt lgkmcnt(2)
v_mfma_f32_16x16x16_bf16 v[16:19], v[84:85], v[50:51], v[16:19]
v_mfma_f32_16x16x16_bf16 v[20:23], v[86:87], v[50:51], v[20:23]
s_waitcnt lgkmcnt(1)
v_mfma_f32_16x16x16_bf16 v[16:19], v[88:89], v[52:53], v[16:19]
v_mfma_f32_16x16x16_bf16 v[20:23], v[90:91], v[52:53], v[20:23]
s_waitcnt lgkmcnt(0)
v_mfma_f32_16x16x16_bf16 v[16:19], v[92:93], v[54:55], v[16:19]
v_mfma_f32_16x16x16_bf16 v[20:23], v[94:95], v[54:55], v[20:23]
s_mov_b64 exec, 1
v_add_u32 v45, s46, v44
ds_add_u32 v45, v46
s_mov_b64 exec, -1
s_add_u32 s9, s10, 9
s_mul_i32 s13, s10, 205
s_lshr_b32 s13, s13, 12
s_mul_i32 s12, s13, 20
s_sub_u32 s12, s10, s12
s_lshl_b32 s45, s12, 12
s_add_u32 s45, s45, 65536
s_and_b32 s46, s12, 28
s_add_u32 s10, s10, s11
v_lshl_add_u32 v2, v0, 4, s45
v_perm_b32 v56, v26, v26, v3
v_perm_b32 v57, v26, v26, v4
v_perm_b32 v58, v26, v26, v5
v_perm_b32 v59, v26, v26, v6
v_perm_b32 v60, v27, v27, v3
v_perm_b32 v61, v27, v27, v4
v_perm_b32 v62, v27, v27, v5
v_perm_b32 v63, v27, v27, v6
s_cmp_ge_i32 s42, s9
s_cbranch_scc1 L_wd26
s_mov_b32 s43, 0
L_wl25:
ds_read_b32 v8, v44 offset:128
s_waitcnt lgkmcnt(0)
v_readfirstlane_b32 s42, v8
s_cmp_ge_i32 s42, s9
s_cbranch_scc1 L_wd26
s_sleep 1
s_add_u32 s43, s43, 1
s_cmp_lt_u32 s43, 2097152
s_cbranch_scc1 L_wl25
L_wd26:
ds_read_b128 v[96:99], v2 offset:0
ds_read_b128 v[100:103], v2 offset:1024
ds_read_b128 v[104:107], v2 offset:2048
ds_read_b128 v[108:111], v2 offset:3072
s_waitcnt lgkmcnt(3)
v_mfma_f32_16x16x16_bf16 v[16:19], v[96:97], v[56:57], v[16:19]
v_mfma_f32_16x16x16_bf16 v[20:23], v[98:99], v[56:57], v[20:23]
s_waitcnt lgkmcnt(2)
v_mfma_f32_16x16x16_bf16 v[16:19], v[100:101], v[58:59], v[16:19]
v_mfma_f32_16x16x16_bf16 v[20:23], v[102:103], v[58:59], v[20:23]
s_waitcnt lgkmcnt(1)
v_mfma_f32_16x16x16_bf16 v[16:19], v[104:105], v[60:61], v[16:19]
v_mfma_f32_16x16x16_bf16 v[20:23], v[106:107], v[60:61], v[20:23]
s_waitcnt lgkmcnt(0)
v_mfma_f32_16x16x16_bf16 v[16:19], v[108:109], v[62:63], v[16:19]
v_mfma_f32_16x16x16_bf16 v[20:23], v[110:111], v[62:63], v[20:23]
s_mov_b64 exec, 1
v_add_u32 v45, s46, v44
ds_add_u32 v45, v46
s_mov_b64 exec, -1
s_add_u32 s9, s10, 9
s_mul_i32 s13, s10, 205
s_lshr_b32 s13, s13, 12
s_mul_i32 s12, s13, 20
s_sub_u32 s12, s10, s12
s_lshl_b32 s45, s12, 12
s_add_u32 s45, s45, 65536
s_and_b32 s46, s12, 28
s_add_u32 s10, s10, s11
v_lshl_add_u32 v2, v0, 4, s45
v_perm_b32 v48, v28, v28, v3
v_perm_b32 v49, v28, v28, v4
v_perm_b32 v50, v28, v28, v5
v_perm_b32 v51, v28, v28, v6
v_perm_b32 v52, v29, v29, v3
v_perm_b32 v53, v29, v29, v4
v_perm_b32 v54, v29, v29, v5
v_perm_b32 v55, v29, v29, v6
s_cmp_ge_i32 s42, s9
s_cbranch_scc1 L_wd28
s_mov_b32 s43, 0
L_wl27:
ds_read_b32 v8, v44 offset:128
s_waitcnt lgkmcnt(0)
v_readfirstlane_b32 s42, v8
s_cmp_ge_i32 s42, s9
s_cbranch_scc1 L_wd28
s_sleep 1
s_add_u32 s43, s43, 1
s_cmp_lt_u32 s43, 2097152
s_cbranch_scc1 L_wl27
L_wd28:
ds_read_b128 v[80:83], v2 offset:0
ds_read_b128 v[84:87], v2 offset:1024
ds_read_b128 v[88:91], v2 offset:2048
ds_read_b128 v[92:95], v2 offset:3072
s_waitcnt lgkmcnt(3)
v_mfma_f32_16x16x16_bf16 v[16:19], v[80:81], v[48:49], v[16:19]
v_mfma_f32_16x16x16_bf16 v[20:23], v[82:83], v[48:49], v[20:23]
s_waitcnt lgkmcnt(2)
v_mfma_f32_16x16x16_bf16 v[16:19], v[84:85], v[50:51], v[16:19]
v_mfma_f32_16x16x16_bf16 v[20:23], v[86:87], v[50:51], v[20:23]
s_waitcnt lgkmcnt(1)
v_mfma_f32_16x16x16_bf16 v[16:19], v[88:89], v[52:53], v[16:19]
v_mfma_f32_16x16x16_bf16 v[20:23], v[90:91], v[52:53], v[20:23]
s_waitcnt lgkmcnt(0)
v_mfma_f32_16x16x16_bf16 v[16:19], v[92:93], v[54:55], v[16:19]
v_mfma_f32_16x16x16_bf16 v[20:23], v[94:95], v[54:55], v[20:23]
s_mov_b64 exec, 1
v_add_u32 v45, s46, v44
ds_add_u32 v45, v46
s_mov_b64 exec, -1
s_add_u32 s9, s10, 9
s_mul_i32 s13, s10, 205
s_lshr_b32 s13, s13, 12
s_mul_i32 s12, s13, 20
s_sub_u32 s12, s10, s12
s_lshl_b32 s45, s12, 12
s_add_u32 s45, s45, 65536
s_and_b32 s46, s12, 28
s_add_u32 s10, s10, s11
v_lshl_add_u32 v2, v0, 4, s45
v_perm_b32 v56, v30, v30, v3
v_perm_b32 v57, v30, v30, v4
v_perm_b32 v58, v30, v30, v5
v_perm_b32 v59, v30, v30, v6
v_perm_b32 v60, v31, v31, v3
v_perm_b32 v61, v31, v31, v4
v_perm_b32 v62, v31, v31, v5
v_perm_b32 v63, v31, v31, v6
s_cmp_ge_i32 s42, s9
s_cbranch_scc1 L_wd30
s_mov_b32 s43, 0
L_wl29:
ds_read_b32 v8, v44 offset:128
s_waitcnt lgkmcnt(0)
v_readfirstlane_b32 s42, v8
s_cmp_ge_i32 s42, s9
s_cbranch_scc1 L_wd30
s_sleep 1
s_add_u32 s43, s43, 1
s_cmp_lt_u32 s43, 2097152
s_cbranch_scc1 L_wl29
L_wd30:
ds_read_b128 v[96:99], v2 offset:0
ds_read_b128 v[100:103], v2 offset:1024
ds_read_b128 v[104:107], v2 offset:2048
ds_read_b128 v[108:111], v2 offset:3072
s_waitcnt lgkmcnt(3)
v_mfma_f32_16x16x16_bf16 v[16:19], v[96:97], v[56:57], v[16:19]
v_mfma_f32_16x16x16_bf16 v[20:23], v[98:99], v[56:57], v[20:23]
s_waitcnt lgkmcnt(2)
v_mfma_f32_16x16x16_bf16 v[16:19], v[100:101], v[58:59], v[16:19]
v_mfma_f32_16x16x16_bf16 v[20:23], v[102:103], v[58:59], v[20:23]
s_waitcnt lgkmcnt(1)
v_mfma_f32_16x16x16_bf16 v[16:19], v[104:105], v[60:61], v[16:19]
v_mfma_f32_16x16x16_bf16 v[20:23], v[106:107], v[60:61], v[20:23]
s_waitcnt lgkmcnt(0)
v_mfma_f32_16x16x16_bf16 v[16:19], v[108:109], v[62:63], v[16:19]
v_mfma_f32_16x16x16_bf16 v[20:23], v[110:111], v[62:63], v[20:23]
s_mov_b64 exec, 1
v_add_u32 v45, s46, v44
ds_add_u32 v45, v46
s_mov_b64 exec, -1
s_add_u32 s9, s10, 9
s_mul_i32 s13, s10, 205
s_lshr_b32 s13, s13, 12
s_mul_i32 s12, s13, 20
s_sub_u32 s12, s10, s12
s_lshl_b32 s45, s12, 12
s_add_u32 s45, s45, 65536
s_and_b32 s46, s12, 28
s_add_u32 s10, s10, s11
v_lshl_add_u32 v2, v0, 4, s45
v_perm_b32 v48, v32, v32, v3
v_perm_b32 v49, v32, v32, v4
v_perm_b32 v50, v32, v32, v5
v_perm_b32 v51, v32, v32, v6
v_perm_b32 v52, v33, v33, v3
v_perm_b32 v53, v33, v33, v4
v_perm_b32 v54, v33, v33, v5
v_perm_b32 v55, v33, v33, v6
s_cmp_ge_i32 s42, s9
s_cbranch_scc1 L_wd32
s_mov_b32 s43, 0
L_wl31:
ds_read_b32 v8, v44 offset:128
s_waitcnt lgkmcnt(0)
v_readfirstlane_b32 s42, v8
s_cmp_ge_i32 s42, s9
s_cbranch_scc1 L_wd32
s_sleep 1
s_add_u32 s43, s43, 1
s_cmp_lt_u32 s43, 2097152
s_cbranch_scc1 L_wl31
L_wd32:
ds_read_b128 v[80:83], v2 offset:0
ds_read_b128 v[84:87], v2 offset:1024
ds_read_b128 v[88:91], v2 offset:2048
ds_read_b128 v[92:95], v2 offset:3072
s_waitcnt lgkmcnt(3)
v_mfma_f32_16x16x16_bf16 v[16:19], v[80:81], v[48:49], v[16:19]
v_mfma_f32_16x16x16_bf16 v[20:23], v[82:83], v[48:49], v[20:23]
s_waitcnt lgkmcnt(2)
v_mfma_f32_16x16x16_bf16 v[16:19], v[84:85], v[50:51], v[16:19]
v_mfma_f32_16x16x16_bf16 v[20:23], v[86:87], v[50:51], v[20:23]
s_waitcnt lgkmcnt(1)
v_mfma_f32_16x16x16_bf16 v[16:19], v[88:89], v[52:53], v[16:19]
v_mfma_f32_16x16x16_bf16 v[20:23], v[90:91], v[52:53], v[20:23]
s_waitcnt lgkmcnt(0)
v_mfma_f32_16x16x16_bf16 v[16:19], v[92:93], v[54:55], v[16:19]
v_mfma_f32_16x16x16_bf16 v[20:23], v[94:95], v[54:55], v[20:23]
s_mov_b64 exec, 1
v_add_u32 v45, s46, v44
ds_add_u32 v45, v46
s_mov_b64 exec, -1
s_add_u32 s9, s10, 9
s_mul_i32 s13, s10, 205
s_lshr_b32 s13, s13, 12
s_mul_i32 s12, s13, 20
s_sub_u32 s12, s10, s12
s_lshl_b32 s45, s12, 12
s_add_u32 s45, s45, 65536
s_and_b32 s46, s12, 28
s_add_u32 s10, s10, s11
v_lshl_add_u32 v2, v0, 4, s45
v_perm_b32 v56, v34, v34, v3
v_perm_b32 v57, v34, v34, v4
v_perm_b32 v58, v34, v34, v5
v_perm_b32 v59, v34, v34, v6
v_perm_b32 v60, v35, v35, v3
v_perm_b32 v61, v35, v35, v4
v_perm_b32 v62, v35, v35, v5
v_perm_b32 v63, v35, v35, v6
s_cmp_ge_i32 s42, s9
s_cbranch_scc1 L_wd34
s_mov_b32 s43, 0
L_wl33:
ds_read_b32 v8, v44 offset:128
s_waitcnt lgkmcnt(0)
v_readfirstlane_b32 s42, v8
s_cmp_ge_i32 s42, s9
s_cbranch_scc1 L_wd34
s_sleep 1
s_add_u32 s43, s43, 1
s_cmp_lt_u32 s43, 2097152
s_cbranch_scc1 L_wl33
L_wd34:
ds_read_b128 v[96:99], v2 offset:0
ds_read_b128 v[100:103], v2 offset:1024
ds_read_b128 v[104:107], v2 offset:2048
ds_read_b128 v[108:111], v2 offset:3072
s_waitcnt lgkmcnt(3)
v_mfma_f32_16x16x16_bf16 v[16:19], v[96:97], v[56:57], v[16:19]
v_mfma_f32_16x16x16_bf16 v[20:23], v[98:99], v[56:57], v[20:23]
s_waitcnt lgkmcnt(2)
v_mfma_f32_16x16x16_bf16 v[16:19], v[100:101], v[58:59], v[16:19]
v_mfma_f32_16x16x16_bf16 v[20:23], v[102:103], v[58:59], v[20:23]
s_waitcnt lgkmcnt(1)
v_mfma_f32_16x16x16_bf16 v[16:19], v[104:105], v[60:61], v[16:19]
v_mfma_f32_16x16x16_bf16 v[20:23], v[106:107], v[60:61], v[20:23]
s_waitcnt lgkmcnt(0)
v_mfma_f32_16x16x16_bf16 v[16:19], v[108:109], v[62:63], v[16:19]
v_mfma_f32_16x16x16_bf16 v[20:23], v[110:111], v[62:63], v[20:23]
s_mov_b64 exec, 1
v_add_u32 v45, s46, v44
ds_add_u32 v45, v46
s_mov_b64 exec, -1
s_add_u32 s9, s10, 9
s_mul_i32 s13, s10, 205
s_lshr_b32 s13, s13, 12
s_mul_i32 s12, s13, 20
s_sub_u32 s12, s10, s12
s_lshl_b32 s45, s12, 12
s_add_u32 s45, s45, 65536
s_and_b32 s46, s12, 28
s_add_u32 s10, s10, s11
v_lshl_add_u32 v2, v0, 4, s45
v_perm_b32 v48, v36, v36, v3
v_perm_b32 v49, v36, v36, v4
v_perm_b32 v50, v36, v36, v5
v_perm_b32 v51, v36, v36, v6
v_perm_b32 v52, v37, v37, v3
v_perm_b32 v53, v37, v37, v4
v_perm_b32 v54, v37, v37, v5
v_perm_b32 v55, v37, v37, v6
s_cmp_ge_i32 s42, s9
s_cbranch_scc1 L_wd36
s_mov_b32 s43, 0
L_wl35:
ds_read_b32 v8, v44 offset:128
s_waitcnt lgkmcnt(0)
v_readfirstlane_b32 s42, v8
s_cmp_ge_i32 s42, s9
s_cbranch_scc1 L_wd36
s_sleep 1
s_add_u32 s43, s43, 1
s_cmp_lt_u32 s43, 2097152
s_cbranch_scc1 L_wl35
L_wd36:
ds_read_b128 v[80:83], v2 offset:0
ds_read_b128 v[84:87], v2 offset:1024
ds_read_b128 v[88:91], v2 offset:2048
ds_read_b128 v[92:95], v2 offset:3072
s_waitcnt lgkmcnt(3)
v_mfma_f32_16x16x16_bf16 v[16:19], v[80:81], v[48:49], v[16:19]
v_mfma_f32_16x16x16_bf16 v[20:23], v[82:83], v[48:49], v[20:23]
s_waitcnt lgkmcnt(2)
v_mfma_f32_16x16x16_bf16 v[16:19], v[84:85], v[50:51], v[16:19]
v_mfma_f32_16x16x16_bf16 v[20:23], v[86:87], v[50:51], v[20:23]
s_waitcnt lgkmcnt(1)
v_mfma_f32_16x16x16_bf16 v[16:19], v[88:89], v[52:53], v[16:19]
v_mfma_f32_16x16x16_bf16 v[20:23], v[90:91], v[52:53], v[20:23]
s_waitcnt lgkmcnt(0)
v_mfma_f32_16x16x16_bf16 v[16:19], v[92:93], v[54:55], v[16:19]
v_mfma_f32_16x16x16_bf16 v[20:23], v[94:95], v[54:55], v[20:23]
s_mov_b64 exec, 1
v_add_u32 v45, s46, v44
ds_add_u32 v45, v46
s_mov_b64 exec, -1
s_add_u32 s9, s10, 9
s_mul_i32 s13, s10, 205
s_lshr_b32 s13, s13, 12
s_mul_i32 s12, s13, 20
s_sub_u32 s12, s10, s12
s_lshl_b32 s45, s12, 12
s_add_u32 s45, s45, 65536
s_and_b32 s46, s12, 28
s_add_u32 s10, s10, s11
v_lshl_add_u32 v2, v0, 4, s45
v_perm_b32 v56, v38, v38, v3
v_perm_b32 v57, v38, v38, v4
v_perm_b32 v58, v38, v38, v5
v_perm_b32 v59, v38, v38, v6
v_perm_b32 v60, v39, v39, v3
v_perm_b32 v61, v39, v39, v4
v_perm_b32 v62, v39, v39, v5
v_perm_b32 v63, v39, v39, v6
s_lshl_b32 s15, 1, s8
v_mov_b32 v47, s15
s_setprio 2
s_cmp_ge_i32 s42, s9
s_cbranch_scc1 L_wd38
s_mov_b32 s43, 0
L_wl37:
ds_read_b32 v8, v44 offset:128
s_waitcnt lgkmcnt(0)
v_readfirstlane_b32 s42, v8
s_cmp_ge_i32 s42, s9
s_cbranch_scc1 L_wd38
s_add_u32 s43, s43, 1
s_cmp_lt_u32 s43, 2097152
s_cbranch_scc1 L_wl37
L_wd38:
ds_read_b128 v[96:99], v2 offset:0
ds_read_b128 v[100:103], v2 offset:1024
ds_read_b128 v[104:107], v2 offset:2048
ds_read_b128 v[108:111], v2 offset:3072
s_waitcnt lgkmcnt(3)
v_mfma_f32_16x16x16_bf16 v[16:19], v[96:97], v[56:57], v[16:19]
v_mfma_f32_16x16x16_bf16 v[20:23], v[98:99], v[56:57], v[20:23]
s_waitcnt lgkmcnt(2)
v_mfma_f32_16x16x16_bf16 v[16:19], v[100:101], v[58:59], v[16:19]
v_mfma_f32_16x16x16_bf16 v[20:23], v[102:103], v[58:59], v[20:23]
s_waitcnt lgkmcnt(1)
v_mfma_f32_16x16x16_bf16 v[16:19], v[104:105], v[60:61], v[16:19]
v_mfma_f32_16x16x16_bf16 v[20:23], v[106:107], v[60:61], v[20:23]
s_waitcnt lgkmcnt(0)
v_mfma_f32_16x16x16_bf16 v[16:19], v[108:109], v[62:63], v[16:19]
v_mfma_f32_16x16x16_bf16 v[20:23], v[110:111], v[62:63], v[20:23]
s_cmp_ge_u32 s3, 10
s_nop 5
ds_write_b128 v13, v[16:19]
ds_write_b128 v13, v[20:23] offset:1024
s_cbranch_scc1 L_aend
s_waitcnt lgkmcnt(0)
s_barrier
s_cmp_ge_u32 s3, 7
s_cbranch_scc0 L_tail
s_endpgm
L_aend:
s_mov_b64 exec, 1
ds_or_b32 v44, v47 offset:96
v_add_u32 v45, s46, v44
ds_add_u32 v45, v46
s_mov_b64 exec, -1
s_branch L_tail
.p2align 12
L_tail:
s_mov_b32 s52, s40
s_mov_b32 s53, s41
s_mov_b32 s54, 3145728
s_mov_b32 s55, 0x20000
v_mov_b32 v44, 152000
s_and_b32 s17, s16, 63
s_bfe_u32 s18, s16, 0x60008
s_bfe_u32 s19, s16, 0x60010
s_bfe_u32 s20, s16, 0x60018
v_mov_b32 v14, 63
s_sub_u32 s21, s3, 3
s_cmp_lt_u32 s21, 4
s_cbranch_scc1 L_poll1
s_sub_u32 s21, s3, 1
s_sub_u32 s22, s3, 8
s_cmp_ge_u32 s3, 10
s_cselect_b32 s21, s22, s21
v_lshrrev_b32 v28, 5, v0
v_lshlrev_b32 v28, 13, v28
v_bfe_u32 v2, v0, 4, 1
v_lshl_add_u32 v28, v2, 9, v28
v_bfe_u32 v2, v0, 2, 2
v_lshl_add_u32 v28, v2, 11, v28
v_and_b32 v2, 3, v0
v_lshl_add_u32 v28, v2, 3, v28
v_bfe_u32 v2, v0, 2, 3
v_lshlrev_b32 v2, 5, v2
s_lshl_b32 s12, s21, 6
v_xor_b32 v2, s12, v2
v_add_u32 v28, v28, v2
v_xor_b32 v31, 32, v28
v_and_b32 v30, 7, v0
v_mul_u32_u24 v29, 272, v30
v_lshrrev_b32 v3, 4, v0
v_lshl_add_u32 v29, v3, 4, v29
v_add_u32 v29, 149824, v29
v_lshlrev_b32 v30, 16, v30
v_lshl_add_u32 v30, v3, 4, v30
v_bfe_u32 v3, v0, 3, 1
v_lshl_add_u32 v30, v3, 6, v30
s_lshr_b32 s24, s5, 4
s_lshl_b32 s24, s24, 19
s_and_b32 s10, s5, 3
s_lshl_b32 s10, s10, 2
s_add_u32 s10, s10, s21
s_lshl_b32 s10, s10, 12
s_add_u32 s24, s24, s10
s_lshl_b32 s10, s4, 2
s_bfe_u32 s11, s5, 0x20002
s_add_u32 s10, s10, s11
s_lshl_b32 s10, s10, 7
s_add_u32 s24, s24, s10
s_add_u32 s24, s24, 2097152
s_mov_b32 s22, 0x00ff00ff
s_mov_b32 s23, 0x00ff00ff
s_cmp_lt_u32 s3, 10
s_cbranch_scc1 L_oproj
s_sub_u32 s8, s3, 10
s_lshl_b32 s9, s8, 10
s_add_u32 s9, s9, 0
v_lshl_add_u32 v1, v0, 4, s9
v_bfe_u32 v3, v0, 2, 2
v_mul_u32_u24 v2, 80, v3
v_add_u32 v2, 149504, v2
s_lshl_b32 s10, s6, 2
s_add_u32 s10, s10, s7
s_lshl_b32 s11, s4, 16
s_lshl_b32 s12, s10, 9
s_add_u32 s11, s11, s12
s_lshl_b32 s12, s8, 8
s_add_u32 s11, s11, s12
s_add_u32 s11, s11, 1048576
s_lshl_b32 s13, s4, 12
s_lshl_b32 s12, s10, 7
s_add_u32 s13, s13, s12
s_add_u32 s13, s13, 65536
v_lshlrev_b32 v4, 14, v3
v_lshrrev_b32 v5, 4, v0
v_lshl_add_u32 v4, v5, 6, v4
v_and_b32 v5, 3, v0
v_lshl_add_u32 v4, v5, 4, v4
v_lshlrev_b32 v3, 3, v3
v_mov_b32 v11, s16
v_mov_b32 v37, s16
s_add_u32 s26, s11, 0x80000
s_add_u32 s27, s13, 0x8000
s_mov_b32 s43, 0
L_dl39:
ds_read_b32 v8, v44 offset:96
s_waitcnt lgkmcnt(0)
v_readfirstlane_b32 s15, v8
s_and_b32 s15, s15, 768
s_cmp_eq_u32 s15, 768
s_cbranch_scc1 L_dd40
s_sleep 2
s_add_u32 s43, s43, 1
s_cmp_lt_u32 s43, 2097152
s_cbranch_scc1 L_dl39
L_dd40:
ds_read_b128 v[48:51], v2 offset:64
s_waitcnt lgkmcnt(0)
v_max_f32 v12, v48, v50
v_sub_f32 v48, v48, v12
v_sub_f32 v50, v50, v12
v_exp_f32 v48, v48
v_exp_f32 v50, v50
s_nop 0
v_mul_f32 v9, v48, v49
v_fmac_f32 v9, v50, v51
v_log_f32 v36, v9
v_rcp_f32 v9, v9
s_nop 0
v_add_f32 v36, v36, v12
v_mul_f32 v48, v9, v48
v_mul_f32 v50, v9, v50
ds_read_b128 v[64:67], v1 offset:16384
ds_read_b128 v[68:71], v1 offset:18432
s_waitcnt lgkmcnt(1)
v_mul_f32 v32, v48, v64
v_mul_f32 v33, v48, v65
v_mul_f32 v34, v48, v66
v_mul_f32 v35, v48, v67
s_waitcnt lgkmcnt(0)
v_fmac_f32 v32, v50, v68
v_fmac_f32 v33, v50, v69
v_fmac_f32 v34, v50, v70
v_fmac_f32 v35, v50, v71
v_bfi_b32 v32, v14, s17, v32
v_bfi_b32 v33, v14, s18, v33
v_bfi_b32 v34, v14, s19, v34
v_bfi_b32 v35, v14, s20, v35
s_cmp_ge_i32 s42, 140
s_cbranch_scc1 L_wd42
s_mov_b32 s43, 0
L_wl41:
ds_read_b32 v8, v44 offset:128
s_waitcnt lgkmcnt(0)
v_readfirstlane_b32 s42, v8
s_cmp_ge_i32 s42, 140
s_cbranch_scc1 L_wd42
s_sleep 8
s_add_u32 s43, s43, 1
s_cmp_lt_u32 s43, 2097152
s_cbranch_scc1 L_wl41
L_wd42:
ds_read_b128 v[48:51], v2 offset:0
ds_read_b128 v[52:55], v2 offset:16
ds_read_b128 v[56:59], v2 offset:32
ds_read_b128 v[60:63], v2 offset:48
s_waitcnt lgkmcnt(0)
v_max_f32 v12, v48, v50
v_max3_f32 v12, v52, v54, v12
v_max3_f32 v12, v56, v58, v12
v_max3_f32 v12, v60, v62, v12
v_sub_f32 v48, v48, v12
v_sub_f32 v50, v50, v12
v_sub_f32 v52, v52, v12
v_sub_f32 v54, v54, v12
v_sub_f32 v56, v56, v12
v_sub_f32 v58, v58, v12
v_sub_f32 v60, v60, v12
v_sub_f32 v62, v62, v12
v_exp_f32 v48, v48
v_exp_f32 v50, v50
v_exp_f32 v52, v52
v_exp_f32 v54, v54
v_exp_f32 v56, v56
v_exp_f32 v58, v58
v_exp_f32 v60, v60
v_exp_f32 v62, v62
s_nop 0
v_mul_f32 v9, v48, v49
v_fmac_f32 v9, v50, v51
v_fmac_f32 v9, v52, v53
v_fmac_f32 v9, v54, v55
v_fmac_f32 v9, v56, v57
v_fmac_f32 v9, v58, v59
v_fmac_f32 v9, v60, v61
v_fmac_f32 v9, v62, v63
v_log_f32 v10, v9
v_rcp_f32 v9, v9
s_nop 0
v_add_f32 v10, v10, v12
v_mul_f32 v48, v9, v48
v_mul_f32 v50, v9, v50
v_mul_f32 v52, v9, v52
v_mul_f32 v54, v9, v54
v_mul_f32 v56, v9, v56
v_mul_f32 v58, v9, v58
v_mul_f32 v60, v9, v60
v_mul_f32 v62, v9, v62
s_cmp_ge_i32 s42, 164
s_cbranch_scc1 L_wd44
s_mov_b32 s43, 0
L_wl43:
ds_read_b32 v8, v44 offset:128
s_waitcnt lgkmcnt(0)
v_readfirstlane_b32 s42, v8
s_cmp_ge_i32 s42, 164
s_cbranch_scc1 L_wd44
s_sleep 2
s_add_u32 s43, s43, 1
s_cmp_lt_u32 s43, 2097152
s_cbranch_scc1 L_wl43
L_wd44:
buffer_store_dwordx4 v[32:35], v4, s[52:55], s11 offen sc1
s_cmp_eq_u32 s8, 0
s_cbranch_scc0 L_nh45
s_mov_b64 exec, 0x1111
buffer_store_dwordx2 v[36:37], v3, s[52:55], s13 offen sc1
s_mov_b64 exec, -1
L_nh45:
s_barrier
ds_read_b128 v[64:67], v1 offset:0
ds_read_b128 v[68:71], v1 offset:2048
ds_read_b128 v[72:75], v1 offset:4096
ds_read_b128 v[76:79], v1 offset:6144
ds_read_b128 v[80:83], v1 offset:8192
ds_read_b128 v[84:87], v1 offset:10240
ds_read_b128 v[88:91], v1 offset:12288
ds_read_b128 v[92:95], v1 offset:14336
s_cmp_eq_u32 s8, 0
s_cbranch_scc0 L_nh46
s_mov_b64 exec, 0x1111
buffer_store_dwordx2 v[10:11], v3, s[52:55], s27 offen sc1
s_mov_b64 exec, -1
L_nh46:
s_waitcnt lgkmcnt(7)
v_mul_f32 v24, v48, v64
v_mul_f32 v25, v48, v65
v_mul_f32 v26, v48, v66
v_mul_f32 v27, v48, v67
s_waitcnt lgkmcnt(6)
v_fmac_f32 v24, v50, v68
v_fmac_f32 v25, v50, v69
v_fmac_f32 v26, v50, v70
v_fmac_f32 v27, v50, v71
s_waitcnt lgkmcnt(5)
v_fmac_f32 v24, v52, v72
v_fmac_f32 v25, v52, v73
v_fmac_f32 v26, v52, v74
v_fmac_f32 v27, v52, v75
s_waitcnt lgkmcnt(4)
v_fmac_f32 v24, v54, v76
v_fmac_f32 v25, v54, v77
v_fmac_f32 v26, v54, v78
v_fmac_f32 v27, v54, v79
s_waitcnt lgkmcnt(3)
v_fmac_f32 v24, v56, v80
v_fmac_f32 v25, v56, v81
v_fmac_f32 v26, v56, v82
v_fmac_f32 v27, v56, v83
s_waitcnt lgkmcnt(2)
v_fmac_f32 v24, v58, v84
v_fmac_f32 v25, v58, v85
v_fmac_f32 v26, v58, v86
v_fmac_f32 v27, v58, v87
s_waitcnt lgkmcnt(1)
v_fmac_f32 v24, v60, v88
v_fmac_f32 v25, v60, v89
v_fmac_f32 v26, v60, v90
v_fmac_f32 v27, v60, v91
s_waitcnt lgkmcnt(0)
v_fmac_f32 v24, v62, v92
v_fmac_f32 v25, v62, v93
v_fmac_f32 v26, v62, v94
v_fmac_f32 v27, v62, v95
v_bfi_b32 v24, v14, s17, v24
v_bfi_b32 v25, v14, s18, v25
v_bfi_b32 v26, v14, s19, v26
v_bfi_b32 v27, v14, s20, v27
buffer_store_dwordx4 v[24:27], v4, s[52:55], s26 offen sc1
L_oproj:
s_cmp_ge_i32 s42, 172
s_cbranch_scc1 L_wd48
s_mov_b32 s43, 0
L_wl47:
ds_read_b32 v8, v44 offset:128
s_waitcnt lgkmcnt(0)
v_readfirstlane_b32 s42, v8
s_cmp_ge_i32 s42, 172
s_cbranch_scc1 L_wd48
s_sleep 1
s_add_u32 s43, s43, 1
s_cmp_lt_u32 s43, 2097152
s_cbranch_scc1 L_wl47
L_wd48:
ds_read_b64_tr_b16 v[96:97], v28 offset:32768
ds_read_b64_tr_b16 v[98:99], v28 offset:33024
ds_read_b64_tr_b16 v[104:105], v28 offset:33792
ds_read_b64_tr_b16 v[106:107], v28 offset:34048
ds_read_b64_tr_b16 v[112:113], v31 offset:32768
ds_read_b64_tr_b16 v[114:115], v31 offset:33024
ds_read_b64_tr_b16 v[120:121], v31 offset:33792
ds_read_b64_tr_b16 v[122:123], v31 offset:34048
s_waitcnt lgkmcnt(0)
s_cmp_ge_i32 s42, 176
s_cbranch_scc1 L_wd50
s_mov_b32 s43, 0
L_wl49:
ds_read_b32 v8, v44 offset:128
s_waitcnt lgkmcnt(0)
v_readfirstlane_b32 s42, v8
s_cmp_ge_i32 s42, 176
s_cbranch_scc1 L_wd50
s_sleep 1
s_add_u32 s43, s43, 1
s_cmp_lt_u32 s43, 2097152
s_cbranch_scc1 L_wl49
L_wd50:
ds_read_b64_tr_b16 v[100:101], v28 offset:49152
ds_read_b64_tr_b16 v[102:103], v28 offset:49408
ds_read_b64_tr_b16 v[108:109], v28 offset:50176
ds_read_b64_tr_b16 v[110:111], v28 offset:50432
ds_read_b64_tr_b16 v[116:117], v31 offset:49152
ds_read_b64_tr_b16 v[118:119], v31 offset:49408
ds_read_b64_tr_b16 v[124:125], v31 offset:50176
ds_read_b64_tr_b16 v[126:127], v31 offset:50432
s_waitcnt lgkmcnt(0)
s_barrier
ds_read_b128 v[128:131], v29 offset:0
ds_read_b128 v[132:135], v29 offset:64
ds_read_b128 v[136:139], v29 offset:128
ds_read_b128 v[140:143], v29 offset:192
s_waitcnt lgkmcnt(3)
v_mfma_f32_16x16x32_bf16 v[32:35], v[96:99], v[128:131], 0
v_mfma_f32_16x16x32_bf16 v[36:39], v[112:115], v[128:131], 0
s_waitcnt lgkmcnt(2)
v_mfma_f32_16x16x32_bf16 v[32:35], v[100:103], v[132:135], v[32:35]
v_mfma_f32_16x16x32_bf16 v[36:39], v[116:119], v[132:135], v[36:39]
s_waitcnt lgkmcnt(1)
v_mfma_f32_16x16x32_bf16 v[32:35], v[104:107], v[136:139], v[32:35]
v_mfma_f32_16x16x32_bf16 v[36:39], v[120:123], v[136:139], v[36:39]
s_waitcnt lgkmcnt(0)
v_mfma_f32_16x16x32_bf16 v[32:35], v[108:111], v[140:143], v[32:35]
v_mfma_f32_16x16x32_bf16 v[36:39], v[124:127], v[140:143], v[36:39]
s_nop 7
v_cndmask_b32 v32, v36, v32, s[22:23]
v_cndmask_b32 v33, v37, v33, s[22:23]
v_cndmask_b32 v34, v38, v34, s[22:23]
v_cndmask_b32 v35, v39, v35, s[22:23]
v_bfi_b32 v32, v14, s17, v32
v_bfi_b32 v33, v14, s18, v33
v_bfi_b32 v34, v14, s19, v34
v_bfi_b32 v35, v14, s20, v35
buffer_store_dwordx4 v[32:35], v30, s[52:55], s24 offen sc1
s_cmp_eq_u32 s3, 1
s_cbranch_scc0 L_end
s_lshl_b32 s26, s2, 12
s_add_u32 s26, s26, 2097152
v_lshlrev_b32 v40, 4, v0
s_mov_b32 s56, s36
s_mov_b32 s57, s37
s_mov_b32 s58, 16384
s_mov_b32 s59, 0x20000
s_bfe_u32 s27, s2, 0x30004
s_lshl_b32 s27, s27, 11
s_lshr_b32 s11, s2, 7
s_lshl_b32 s11, s11, 10
s_add_u32 s27, s27, s11
s_and_b32 s11, s2, 15
s_lshl_b32 s11, s11, 6
s_add_u32 s27, s27, s11
v_and_b32 v41, 7, v0
v_lshlrev_b32 v41, 3, v41
v_lshrrev_b32 v3, 4, v0
v_lshl_add_u32 v41, v3, 1, v41
s_mov_b64 s[28:29], -1
s_mov_b64 s[30:31], -1
s_mov_b64 s[32:33], -1
s_mov_b64 s[34:35], -1
s_mov_b32 s14, 0
s_waitcnt vmcnt(0)
L_p2loop:
s_mov_b64 exec, s[28:29]
s_cbranch_execz L_p2s0
buffer_load_dwordx4 v[48:51], v40, s[52:55], s26 offen offset:0 sc1
L_p2s0:
s_mov_b64 exec, s[30:31]
s_cbranch_execz L_p2s1
buffer_load_dwordx4 v[52:55], v40, s[52:55], s26 offen offset:1024 sc1
L_p2s1:
s_mov_b64 exec, s[32:33]
s_cbranch_execz L_p2s2
buffer_load_dwordx4 v[56:59], v40, s[52:55], s26 offen offset:2048 sc1
L_p2s2:
s_mov_b64 exec, s[34:35]
s_cbranch_execz L_p2s3
buffer_load_dwordx4 v[60:63], v40, s[52:55], s26 offen offset:3072 sc1
L_p2s3:
s_mov_b64 exec, -1
s_waitcnt vmcnt(0)
s_cmp_eq_u64 s[28:29], 0
s_cbranch_scc1 L_p2c0
v_xor_b32 v64, s17, v48
v_xor_b32 v65, s18, v49
v_xor_b32 v66, s19, v50
v_xor_b32 v67, s20, v51
v_or3_b32 v8, v64, v65, v66
v_bitop3_b32 v8, v8, v67, v14 bitop3:0xa8
v_cmp_ne_u32 vcc, 0, v8
s_wqm_b64 s[28:29], vcc
L_p2c0:
s_cmp_eq_u64 s[30:31], 0
s_cbranch_scc1 L_p2c1
v_xor_b32 v68, s17, v52
v_xor_b32 v69, s18, v53
v_xor_b32 v70, s19, v54
v_xor_b32 v71, s20, v55
v_or3_b32 v8, v68, v69, v70
v_bitop3_b32 v8, v8, v71, v14 bitop3:0xa8
v_cmp_ne_u32 vcc, 0, v8
s_wqm_b64 s[30:31], vcc
L_p2c1:
s_cmp_eq_u64 s[32:33], 0
s_cbranch_scc1 L_p2c2
v_xor_b32 v72, s17, v56
v_xor_b32 v73, s18, v57
v_xor_b32 v74, s19, v58
v_xor_b32 v75, s20, v59
v_or3_b32 v8, v72, v73, v74
v_bitop3_b32 v8, v8, v75, v14 bitop3:0xa8
v_cmp_ne_u32 vcc, 0, v8
s_wqm_b64 s[32:33], vcc
L_p2c2:
s_cmp_eq_u64 s[34:35], 0
s_cbranch_scc1 L_p2c3
v_xor_b32 v76, s17, v60
v_xor_b32 v77, s18, v61
v_xor_b32 v78, s19, v62
v_xor_b32 v79, s20, v63
v_or3_b32 v8, v76, v77, v78
v_bitop3_b32 v8, v8, v79, v14 bitop3:0xa8
v_cmp_ne_u32 vcc, 0, v8
s_wqm_b64 s[34:35], vcc
L_p2c3:
s_or_b64 s[60:61], s[28:29], s[30:31]
s_or_b64 s[62:63], s[32:33], s[34:35]
s_or_b64 s[60:61], s[60:61], s[62:63]
s_cbranch_scc0 L_p2done
s_sleep 1
s_add_u32 s14, s14, 1
s_cmp_lt_u32 s14, 262144
s_cbranch_scc1 L_p2loop
L_p2done:
v_add_f32 v64, v64, v68
v_add_f32 v72, v72, v76
v_add_f32 v65, v65, v69
v_add_f32 v73, v73, v77
v_add_f32 v66, v66, v70
v_add_f32 v74, v74, v78
v_add_f32 v67, v67, v71
v_add_f32 v75, v75, v79
v_add_f32 v64, v64, v72
v_add_f32 v65, v65, v73
v_add_f32 v66, v66, v74
v_add_f32 v67, v67, v75
s_nop 0
v_permlane32_swap_b32 v64, v66
v_permlane32_swap_b32 v65, v67
v_add_f32 v64, v64, v66
v_add_f32 v65, v65, v67
s_nop 1
v_permlane16_swap_b32 v64, v65
v_add_f32 v64, v64, v65
s_nop 1
v_add_f32_dpp v64, v64, v64 row_ror:8 row_mask:0xf bank_mask:0xf
v_cvt_pk_bf16_f32 v64, v64, v64
s_mov_b64 exec, s[22:23]
buffer_store_short v64, v41, s[56:59], s27 offen
s_cmp_eq_u32 s2, 128
s_cbranch_scc0 L_noep
s_mov_b64 exec, 1
v_mov_b32 v3, 0
v_mov_b32 v4, s16
buffer_store_dword v4, v3, s[52:55], 0 offen sc1
L_noep:
s_endpgm
L_poll1:
s_lshr_b32 s9, s5, 4
s_lshl_b32 s9, s9, 3
s_add_u32 s9, s9, s4
s_lshl_b32 s9, s9, 2
s_bfe_u32 s10, s5, 0x20002
s_add_u32 s9, s9, s10
s_lshl_b32 s11, s9, 14
s_lshl_b32 s12, s21, 12
s_add_u32 s11, s11, s12
s_add_u32 s11, s11, 1048576
s_lshr_b32 s13, s9, 2
s_lshl_b32 s13, s13, 12
s_lshl_b32 s12, s21, 10
s_add_u32 s13, s13, s12
s_and_b32 s12, s9, 3
s_lshl_b32 s12, s12, 3
s_add_u32 s13, s13, s12
s_add_u32 s13, s13, 65536
v_lshrrev_b32 v3, 5, v0
v_and_b32 v4, 31, v0
v_lshlrev_b32 v1, 11, v3
v_lshl_add_u32 v1, v4, 4, v1
v_lshlrev_b32 v5, 9, v3
s_mul_i32 s12, s21, 544
s_add_u32 s12, s12, 149824
v_mul_u32_u24 v3, 272, v3
v_lshl_add_u32 v3, v4, 3, v3
v_add_u32 v3, s12, v3
s_mov_b64 s[24:25], -1
s_mov_b64 s[26:27], -1
s_mov_b64 s[28:29], -1
s_mov_b64 s[30:31], -1
s_mov_b32 s14, 0
s_cmp_ge_i32 s42, 176
s_cbranch_scc1 L_wd52
s_mov_b32 s43, 0
L_wl51:
ds_read_b32 v8, v44 offset:128
s_waitcnt lgkmcnt(0)
v_readfirstlane_b32 s42, v8
s_cmp_ge_i32 s42, 176
s_cbranch_scc1 L_wd52
s_sleep 1
s_add_u32 s43, s43, 1
s_cmp_lt_u32 s43, 2097152
s_cbranch_scc1 L_wl51
L_wd52:
L_h1loop:
buffer_load_dwordx2 v[56:57], v5, s[52:55], s13 offen offset:0 sc1
buffer_load_dwordx2 v[58:59], v5, s[52:55], s13 offen offset:128 sc1
buffer_load_dwordx2 v[60:61], v5, s[52:55], s13 offen offset:256 sc1
buffer_load_dwordx2 v[62:63], v5, s[52:55], s13 offen offset:384 sc1
s_waitcnt vmcnt(0)
v_xor_b32 v12, s16, v57
v_bitop3_b32 v12, v12, v59, s16 bitop3:0xf6
v_bitop3_b32 v12, v12, v61, s16 bitop3:0xf6
v_bitop3_b32 v12, v12, v63, s16 bitop3:0xf6
v_cmp_ne_u32 vcc, 0, v12
s_cbranch_vccz L_p1go
L_h1back:
s_sleep 3
s_add_u32 s14, s14, 1
s_cmp_lt_u32 s14, 262144
s_cbranch_scc1 L_h1loop
s_branch L_p1done
L_p1go:
s_mov_b64 exec, s[24:25]
s_cbranch_execz L_p1s0
buffer_load_dwordx4 v[64:67], v1, s[52:55], s11 offen offset:0 sc1
L_p1s0:
s_mov_b64 exec, s[26:27]
s_cbranch_execz L_p1s1
buffer_load_dwordx4 v[68:71], v1, s[52:55], s11 offen offset:512 sc1
L_p1s1:
s_mov_b64 exec, s[28:29]
s_cbranch_execz L_p1s2
buffer_load_dwordx4 v[72:75], v1, s[52:55], s11 offen offset:1024 sc1
L_p1s2:
s_mov_b64 exec, s[30:31]
s_cbranch_execz L_p1s3
buffer_load_dwordx4 v[76:79], v1, s[52:55], s11 offen offset:1536 sc1
L_p1s3:
s_mov_b64 exec, -1
v_max3_f32 v8, v56, v58, v60
v_max_f32 v8, v8, v62
v_sub_f32 v56, v56, v8
v_sub_f32 v58, v58, v8
v_sub_f32 v60, v60, v8
v_sub_f32 v62, v62, v8
v_exp_f32 v56, v56
v_exp_f32 v58, v58
v_exp_f32 v60, v60
v_exp_f32 v62, v62
s_nop 0
v_add_f32 v9, v56, v58
v_add_f32 v10, v60, v62
v_add_f32 v9, v9, v10
v_rcp_f32 v9, v9
s_mov_b64 s[56:57], 0
v_mul_f32 v56, v9, v56
v_mul_f32 v58, v9, v58
v_mul_f32 v60, v9, v60
v_mul_f32 v62, v9, v62
s_waitcnt vmcnt(0)
v_xor_b32 v80, s17, v64
v_xor_b32 v81, s18, v65
v_xor_b32 v82, s19, v66
v_xor_b32 v83, s20, v67
v_or3_b32 v8, v80, v81, v82
v_bitop3_b32 v8, v8, v83, v14 bitop3:0xa8
v_cmp_ne_u32 vcc, 0, v8
v_mul_f32 v24, v56, v80
v_mul_f32 v25, v56, v81
v_mul_f32 v26, v56, v82
v_mul_f32 v27, v56, v83
s_wqm_b64 s[24:25], vcc
s_or_b64 s[56:57], s[56:57], vcc
v_xor_b32 v84, s17, v68
v_xor_b32 v85, s18, v69
v_xor_b32 v86, s19, v70
v_xor_b32 v87, s20, v71
v_or3_b32 v8, v84, v85, v86
v_bitop3_b32 v8, v8, v87, v14 bitop3:0xa8
v_cmp_ne_u32 vcc, 0, v8
v_fmac_f32 v24, v58, v84
v_fmac_f32 v25, v58, v85
v_fmac_f32 v26, v58, v86
v_fmac_f32 v27, v58, v87
s_wqm_b64 s[26:27], vcc
s_or_b64 s[56:57], s[56:57], vcc
v_xor_b32 v88, s17, v72
v_xor_b32 v89, s18, v73
v_xor_b32 v90, s19, v74
v_xor_b32 v91, s20, v75
v_or3_b32 v8, v88, v89, v90
v_bitop3_b32 v8, v8, v91, v14 bitop3:0xa8
v_cmp_ne_u32 vcc, 0, v8
v_fmac_f32 v24, v60, v88
v_fmac_f32 v25, v60, v89
v_fmac_f32 v26, v60, v90
v_fmac_f32 v27, v60, v91
s_wqm_b64 s[28:29], vcc
s_or_b64 s[56:57], s[56:57], vcc
v_xor_b32 v92, s17, v76
v_xor_b32 v93, s18, v77
v_xor_b32 v94, s19, v78
v_xor_b32 v95, s20, v79
v_or3_b32 v8, v92, v93, v94
v_bitop3_b32 v8, v8, v95, v14 bitop3:0xa8
v_cmp_ne_u32 vcc, 0, v8
v_fmac_f32 v24, v62, v92
v_fmac_f32 v25, v62, v93
v_fmac_f32 v26, v62, v94
v_fmac_f32 v27, v62, v95
s_wqm_b64 s[30:31], vcc
s_or_b64 s[56:57], s[56:57], vcc
v_cvt_pk_bf16_f32 v24, v24, v25
v_cvt_pk_bf16_f32 v25, v26, v27
s_cbranch_scc1 L_h1back
L_p1done:
ds_write_b64 v3, v[24:25]
s_waitcnt lgkmcnt(0)
s_barrier
L_end:
s_endpgm
.section .rodata,"a"
.p2align 6
.amdhsa_kernel concat_heads__sliding_block_cached__gqa_block_cached__decode_kernel
  .amdhsa_next_free_vgpr 144
  .amdhsa_next_free_sgpr 102
  .amdhsa_accum_offset 144
  .amdhsa_group_segment_fixed_size 0
  .amdhsa_kernarg_size 104
  .amdhsa_user_sgpr_count 2
  .amdhsa_user_sgpr_kernarg_segment_ptr 1
  .amdhsa_system_sgpr_workgroup_id_x 1
.end_amdhsa_kernel
```
